```python
import torch

def _softmax(x, axis=-1):
    return torch.softmax(x, dim=axis)
def _gelu(x):
    return torch.nn.functional.gelu(x, approximate="tanh")
def _silu(x):
    return torch.nn.functional.silu(x)
def _sigmoid(x):
    return torch.sigmoid(x)
def _layernorm(x, axis=-1, eps=1e-5):
    m = x.mean(dim=axis, keepdim=True)
    v = x.var(dim=axis, keepdim=True, unbiased=False)
    return (x - m) / torch.sqrt(v + eps)
def _scatter_add(tgt, idx, src, axis=0):
    return tgt.clone().index_add_(axis, idx, src)
def _segment_sum(src, seg, n):
    out = torch.zeros((n,) + src.shape[1:], dtype=src.dtype)
    return out.index_add_(0, seg, src)
def _pad(x, pw):
    flat = tuple(v for pair in reversed(pw) for v in pair)
    return torch.nn.functional.pad(x, flat)

kernel_name = 'standalone__mha_softmax__near_ridge'

def setup_inputs():

    _w = (lambda a: (lambda t: t.to(torch.bfloat16) if t.is_floating_point() else t)(torch.as_tensor(a)))
    B, H, Sq, Sk, D = 8, 32, 576, 1024, 128
    return {
        "q": _w((lambda *s: torch.randn(*s, dtype=torch.bfloat16) * 0.8)(B, H, Sq, D)),
        "k": _w((lambda *s: torch.randn(*s, dtype=torch.bfloat16) * 0.8)(B, H, Sk, D)),
        "v": _w((lambda *s: torch.randn(*s, dtype=torch.bfloat16) * 0.05)(B, H, Sk, D)),
    }

def reference(q, k, v):
    scale = q.shape[-1] ** -0.5
    scores = torch.einsum("bhqd,bhkd->bhqk", q, k) * scale
    p = _softmax(scores, axis=-1)
    return torch.einsum("bhqk,bhkd->bhqd", p, v)
```

```asm
; @launch grid=(256,1,1) block=(256,1,1) lds=163840
.amdgcn_target "amdgcn-amd-amdhsa--gfx950"
.text
.globl standalone__mha_softmax__near_ridge_kernel
.p2align 8
.type standalone__mha_softmax__near_ridge_kernel,@function
standalone__mha_softmax__near_ridge_kernel:
    s_load_dwordx4 s[36:39], s[0:1], 0
    s_load_dwordx4 s[40:43], s[0:1], 16
    v_and_b32 v255, 63, v0
    v_lshrrev_b32 v1, 6, v0
    s_lshr_b32 s3, s2, 8
    s_cbranch_scc1 L_end
    s_and_b32 s3, s2, 7
    s_lshl_b32 s3, s3, 5
    s_lshr_b32 s2, s2, 3
    s_or_b32 s2, s2, s3
    v_readfirstlane_b32 s4, v1
    v_lshrrev_b32 v5, 4, v255
    v_bfe_u32 v6, v255, 3, 1
    v_lshlrev_b32 v3, 11, v5
    v_lshl_add_u32 v3, v6, 8, v3
    v_and_b32 v6, 7, v255
    v_lshl_add_u32 v3, v6, 4, v3
    s_lshl_b32 s44, s2, 18
    s_lshl_b32 s45, s4, 9
    s_add_u32 s45, s45, s44
    v_add_u32 v8, s45, v3
    s_mul_i32 s35, s4, 1056
    s_add_u32 m0, s35, 25344
    s_waitcnt lgkmcnt(0)
    global_load_lds_dwordx4 v8, s[38:39] nt
    s_add_u32 m0, s35, 29440
    v_and_b32 v6, 15, v255
    global_load_lds_dwordx4 v8, s[38:39] offset:128 nt
    s_add_u32 m0, s35, 59136
    v_lshlrev_b32 v7, 4, v5
    global_load_lds_dwordx4 v8, s[40:41] nt
    s_add_u32 m0, s35, 63232
    v_lshl_add_u32 v19, v6, 8, v7
    global_load_lds_dwordx4 v8, s[40:41] offset:128 nt
    s_mul_i32 s34, s2, 147456
    s_mul_i32 s25, s4, 36864
    s_add_u32 s45, s34, s25
    v_add_u32 v9, s45, v19
    global_load_dwordx4 v[156:159], v9, s[36:37] offset:0 nt
    global_load_dwordx4 v[160:163], v9, s[36:37] offset:64 nt
    global_load_dwordx4 v[164:167], v9, s[36:37] offset:128 nt
    global_load_dwordx4 v[168:171], v9, s[36:37] offset:192 nt
    v_add_u32 v9, 4096, v9
    global_load_dwordx4 v[172:175], v9, s[36:37] offset:0 nt
    global_load_dwordx4 v[176:179], v9, s[36:37] offset:64 nt
    global_load_dwordx4 v[180:183], v9, s[36:37] offset:128 nt
    global_load_dwordx4 v[184:187], v9, s[36:37] offset:192 nt
    s_getpc_b64 s[54:55]
L_pc:
    s_and_b32 s45, s2, 31
    s_lshl_b32 s45, s45, 2
    s_add_u32 s45, s45, s4
    s_lshl_b32 s45, s45, 9
    v_lshlrev_b32 v18, 3, v255
    v_add_u32 v18, s45, v18
    v_min_u32 v18, L_codeend-L_pc-4, v18
    global_load_dword v17, v18, s[54:55]
    s_mov_b32 s14, 262144
    s_mov_b32 s15, 0x00020000
    s_mov_b32 s18, 262144
    s_mov_b32 s19, 0x00020000
    s_mov_b32 s10, 147456
    s_mov_b32 s11, 0x00020000
    s_add_u32 s12, s38, s44
    s_addc_u32 s13, s39, 0
    s_and_b32 s13, s13, 0xffff
    s_add_u32 s16, s40, s44
    s_addc_u32 s17, s41, 0
    s_and_b32 s17, s17, 0xffff
    s_add_u32 s8, s36, s34
    s_addc_u32 s9, s37, 0
    s_and_b32 s9, s9, 0xffff
    s_add_u32 s20, s42, s34
    s_addc_u32 s21, s43, 0
    s_and_b32 s21, s21, 0xffff
    s_mov_b32 s22, 147456
    s_mov_b32 s23, 0x00020000
    s_mov_b32 s24, 0x3e0293ee
    s_mov_b32 s50, 0xffff0000
    v_bfe_u32 v6, v255, 1, 2
    v_mul_u32_u24 v4, 1056, v6
    v_bfe_u32 v6, v255, 3, 1
    v_lshl_add_u32 v4, v6, 8, v4
    v_and_b32 v6, 1, v255
    v_lshl_add_u32 v4, v6, 7, v4
    v_add_u32 v4, v4, v7
    v_bfe_u32 v6, v255, 3, 2
    v_mul_u32_u24 v1, 1056, v6
    v_lshrrev_b32 v6, 5, v255
    v_lshl_add_u32 v1, v6, 8, v1
    v_bfe_u32 v6, v255, 2, 1
    v_lshl_add_u32 v1, v6, 7, v1
    v_and_b32 v6, 3, v255
    v_lshl_add_u32 v1, v6, 3, v1
    s_mul_i32 s34, s4, 16896
    s_add_u32 s34, s34, 67584
    v_add_u32 v2, s34, v4
    v_mov_b32 v0, v4
    v_add_u32 v1, 33792, v1
    s_mov_b32 s27, s35
    s_add_u32 s28, s35, 16896
    s_mov_b32 s29, 16896
    s_lshl_b32 s26, s4, 9
    s_add_u32 s26, s26, 49152
    s_mov_b32 s32, 0
    s_mov_b32 s33, 0
    s_mov_b32 s48, 0x21800000
    s_mov_b32 s49, 0x53800000
    s_waitcnt vmcnt(9)
    s_barrier
    ds_read_b128 a[192:195], v0 offset:25344
    ds_read_b128 a[196:199], v0 offset:25408
    ds_read_b128 a[200:203], v0 offset:29568
    ds_read_b128 a[204:207], v0 offset:29632
    ds_read_b128 a[208:211], v0 offset:25856
    ds_read_b128 a[212:215], v0 offset:25920
    ds_read_b128 a[216:219], v0 offset:30080
    ds_read_b128 a[220:223], v0 offset:30144
    s_waitcnt lgkmcnt(0)
    ds_read_b64_tr_b16 a[224:225], v1 offset:25344
    ds_read_b64_tr_b16 a[226:227], v1 offset:25856
    ds_read_b64_tr_b16 a[228:229], v1 offset:25376
    ds_read_b64_tr_b16 a[230:231], v1 offset:25888
    ds_read_b64_tr_b16 a[232:233], v1 offset:25408
    ds_read_b64_tr_b16 a[234:235], v1 offset:25920
    ds_read_b64_tr_b16 a[236:237], v1 offset:25440
    ds_read_b64_tr_b16 a[238:239], v1 offset:25952
    s_waitcnt lgkmcnt(0)
    ds_read_b64_tr_b16 a[240:241], v1 offset:29568
    ds_read_b64_tr_b16 a[242:243], v1 offset:30080
    ds_read_b64_tr_b16 a[244:245], v1 offset:29600
    ds_read_b64_tr_b16 a[246:247], v1 offset:30112
    ds_read_b64_tr_b16 a[248:249], v1 offset:29632
    ds_read_b64_tr_b16 a[250:251], v1 offset:30144
    ds_read_b64_tr_b16 a[252:253], v1 offset:29664
    ds_read_b64_tr_b16 a[254:255], v1 offset:30176
    s_waitcnt vmcnt(5)
    s_add_u32 s36, s25, 8192
    buffer_load_dwordx4 v[188:191], v19, s[8:11], s36 offen offset:0 nt
    buffer_load_dwordx4 v[192:195], v19, s[8:11], s36 offen offset:64 nt
    buffer_load_dwordx4 v[196:199], v19, s[8:11], s36 offen offset:128 nt
    buffer_load_dwordx4 v[200:203], v19, s[8:11], s36 offen offset:192 nt
    v_lshlrev_b32 v252, 16, v156
    v_and_b32 v253, s50, v156
    v_lshlrev_b32 v254, 16, v157
    v_pk_mul_f32 v[252:253], v[252:253], s[24:25] op_sel_hi:[1,0]
    v_and_b32 v255, s50, v157
    v_pk_mul_f32 v[254:255], v[254:255], s[24:25] op_sel_hi:[1,0]
    v_cvt_pk_bf16_f32 v156, v252, v253
    v_cvt_pk_bf16_f32 v157, v254, v255
    v_lshlrev_b32 v252, 16, v158
    v_and_b32 v253, s50, v158
    v_lshlrev_b32 v254, 16, v159
    v_pk_mul_f32 v[252:253], v[252:253], s[24:25] op_sel_hi:[1,0]
    v_and_b32 v255, s50, v159
    v_pk_mul_f32 v[254:255], v[254:255], s[24:25] op_sel_hi:[1,0]
    v_cvt_pk_bf16_f32 v158, v252, v253
    v_cvt_pk_bf16_f32 v159, v254, v255
    v_lshlrev_b32 v252, 16, v160
    v_and_b32 v253, s50, v160
    v_lshlrev_b32 v254, 16, v161
    v_pk_mul_f32 v[252:253], v[252:253], s[24:25] op_sel_hi:[1,0]
    v_and_b32 v255, s50, v161
    v_pk_mul_f32 v[254:255], v[254:255], s[24:25] op_sel_hi:[1,0]
    v_cvt_pk_bf16_f32 v160, v252, v253
    v_cvt_pk_bf16_f32 v161, v254, v255
    v_lshlrev_b32 v252, 16, v162
    v_and_b32 v253, s50, v162
    v_lshlrev_b32 v254, 16, v163
    v_pk_mul_f32 v[252:253], v[252:253], s[24:25] op_sel_hi:[1,0]
    v_and_b32 v255, s50, v163
    v_pk_mul_f32 v[254:255], v[254:255], s[24:25] op_sel_hi:[1,0]
    v_cvt_pk_bf16_f32 v162, v252, v253
    v_cvt_pk_bf16_f32 v163, v254, v255
    v_lshlrev_b32 v252, 16, v164
    v_and_b32 v253, s50, v164
    v_lshlrev_b32 v254, 16, v165
    v_pk_mul_f32 v[252:253], v[252:253], s[24:25] op_sel_hi:[1,0]
    v_and_b32 v255, s50, v165
    v_pk_mul_f32 v[254:255], v[254:255], s[24:25] op_sel_hi:[1,0]
    v_cvt_pk_bf16_f32 v164, v252, v253
    v_cvt_pk_bf16_f32 v165, v254, v255
    v_lshlrev_b32 v252, 16, v166
    v_and_b32 v253, s50, v166
    v_lshlrev_b32 v254, 16, v167
    v_pk_mul_f32 v[252:253], v[252:253], s[24:25] op_sel_hi:[1,0]
    v_and_b32 v255, s50, v167
    v_pk_mul_f32 v[254:255], v[254:255], s[24:25] op_sel_hi:[1,0]
    v_cvt_pk_bf16_f32 v166, v252, v253
    v_cvt_pk_bf16_f32 v167, v254, v255
    v_lshlrev_b32 v252, 16, v168
    v_and_b32 v253, s50, v168
    v_lshlrev_b32 v254, 16, v169
    v_pk_mul_f32 v[252:253], v[252:253], s[24:25] op_sel_hi:[1,0]
    v_and_b32 v255, s50, v169
    v_pk_mul_f32 v[254:255], v[254:255], s[24:25] op_sel_hi:[1,0]
    v_cvt_pk_bf16_f32 v168, v252, v253
    v_cvt_pk_bf16_f32 v169, v254, v255
    v_lshlrev_b32 v252, 16, v170
    v_and_b32 v253, s50, v170
    v_lshlrev_b32 v254, 16, v171
    v_pk_mul_f32 v[252:253], v[252:253], s[24:25] op_sel_hi:[1,0]
    v_and_b32 v255, s50, v171
    v_pk_mul_f32 v[254:255], v[254:255], s[24:25] op_sel_hi:[1,0]
    v_cvt_pk_bf16_f32 v170, v252, v253
    v_cvt_pk_bf16_f32 v171, v254, v255
    s_nop 1
    v_mfma_f32_16x16x32_bf16 v[20:23], a[192:195], v[156:159], 0
    v_mfma_f32_16x16x32_bf16 v[20:23], a[196:199], v[160:163], v[20:23]
    v_mfma_f32_16x16x32_bf16 v[20:23], a[200:203], v[164:167], v[20:23]
    v_mfma_f32_16x16x32_bf16 v[20:23], a[204:207], v[168:171], v[20:23]
    v_mfma_f32_16x16x32_bf16 v[28:31], a[208:211], v[156:159], 0
    v_mfma_f32_16x16x32_bf16 v[28:31], a[212:215], v[160:163], v[28:31]
    v_mfma_f32_16x16x32_bf16 v[28:31], a[216:219], v[164:167], v[28:31]
    v_mfma_f32_16x16x32_bf16 v[28:31], a[220:223], v[168:171], v[28:31]
    s_waitcnt lgkmcnt(0)
    s_nop 7
    v_max3_f32 v252, v20, v21, v22
    v_max3_f32 v254, v23, v28, v29
    v_max3_f32 v252, v252, v30, v31
    v_max_f32 v252, v252, v254
    v_mov_b32 v254, v252
    s_nop 1
    v_permlane32_swap_b32 v252, v254
    s_nop 0
    v_max_f32 v252, v252, v254
    v_mov_b32 v254, v252
    s_nop 1
    v_permlane16_swap_b32 v252, v254
    s_nop 0
    v_max_f32 v252, v252, v254
    v_sub_f32 v4, 0, v252
    v_sub_f32 v5, 0, v252
    v_sub_f32 v6, 0, v252
    v_sub_f32 v7, 0, v252
    v_sub_f32 v20, v20, v252
    v_sub_f32 v28, v28, v252
    v_sub_f32 v21, v21, v252
    v_sub_f32 v29, v29, v252
    v_sub_f32 v22, v22, v252
    v_sub_f32 v30, v30, v252
    v_sub_f32 v23, v23, v252
    v_sub_f32 v31, v31, v252
    v_mov_b32 v8, 0
    v_mov_b32 v9, 0
    v_mov_b32 v10, 0
    v_mov_b32 v11, 0
    v_mov_b32 v12, 0
    v_mov_b32 v13, 0
    v_mov_b32 v14, 0
    v_mov_b32 v15, 0
    v_mov_b32 v16, 0
    s_nop 1
    v_exp_f32 v20, v20
    s_nop 1
    v_add_f32 v8, v8, v20
    s_nop 1
    v_exp_f32 v21, v21
    s_nop 1
    v_add_f32 v8, v8, v21
    v_cvt_pk_bf16_f32 v36, v20, v21
    s_nop 1
    v_exp_f32 v22, v22
    s_nop 1
    v_add_f32 v8, v8, v22
    s_nop 1
    v_exp_f32 v23, v23
    s_nop 1
    v_add_f32 v8, v8, v23
    v_cvt_pk_bf16_f32 v37, v22, v23
    s_nop 1
    v_exp_f32 v28, v28
    s_nop 0
    s_waitcnt vmcnt(5)
    s_nop 0
    s_lshl_b32 s37, s4, 9
    s_add_u32 s37, s37, 8192
    s_add_u32 m0, s35, 0
    s_nop 0
    buffer_load_dwordx4 v3, s[12:15], s37 offen nt lds
    s_add_u32 m0, s35, 4096
    s_nop 0
    buffer_load_dwordx4 v3, s[12:15], s37 offen offset:128 nt lds
    s_add_u32 m0, s35, 33792
    s_nop 0
    buffer_load_dwordx4 v3, s[16:19], s37 offen nt lds
    s_add_u32 m0, s35, 37888
    s_nop 0
    buffer_load_dwordx4 v3, s[16:19], s37 offen offset:128 nt lds
    v_lshlrev_b32 v252, 16, v172
    v_and_b32 v253, s50, v172
    v_lshlrev_b32 v254, 16, v173
    v_pk_mul_f32 v[252:253], v[252:253], s[24:25] op_sel_hi:[1,0]
    v_and_b32 v255, s50, v173
    v_pk_mul_f32 v[254:255], v[254:255], s[24:25] op_sel_hi:[1,0]
    v_cvt_pk_bf16_f32 v172, v252, v253
    v_cvt_pk_bf16_f32 v173, v254, v255
    v_lshlrev_b32 v252, 16, v174
    v_and_b32 v253, s50, v174
    v_lshlrev_b32 v254, 16, v175
    v_pk_mul_f32 v[252:253], v[252:253], s[24:25] op_sel_hi:[1,0]
    v_and_b32 v255, s50, v175
    v_pk_mul_f32 v[254:255], v[254:255], s[24:25] op_sel_hi:[1,0]
    v_cvt_pk_bf16_f32 v174, v252, v253
    v_cvt_pk_bf16_f32 v175, v254, v255
    v_lshlrev_b32 v252, 16, v176
    v_and_b32 v253, s50, v176
    v_lshlrev_b32 v254, 16, v177
    v_pk_mul_f32 v[252:253], v[252:253], s[24:25] op_sel_hi:[1,0]
    v_and_b32 v255, s50, v177
    v_pk_mul_f32 v[254:255], v[254:255], s[24:25] op_sel_hi:[1,0]
    v_cvt_pk_bf16_f32 v176, v252, v253
    v_cvt_pk_bf16_f32 v177, v254, v255
    v_lshlrev_b32 v252, 16, v178
    v_and_b32 v253, s50, v178
    v_lshlrev_b32 v254, 16, v179
    v_pk_mul_f32 v[252:253], v[252:253], s[24:25] op_sel_hi:[1,0]
    v_and_b32 v255, s50, v179
    v_pk_mul_f32 v[254:255], v[254:255], s[24:25] op_sel_hi:[1,0]
    v_cvt_pk_bf16_f32 v178, v252, v253
    v_cvt_pk_bf16_f32 v179, v254, v255
    v_lshlrev_b32 v252, 16, v180
    v_and_b32 v253, s50, v180
    v_lshlrev_b32 v254, 16, v181
    v_pk_mul_f32 v[252:253], v[252:253], s[24:25] op_sel_hi:[1,0]
    v_and_b32 v255, s50, v181
    v_pk_mul_f32 v[254:255], v[254:255], s[24:25] op_sel_hi:[1,0]
    v_cvt_pk_bf16_f32 v180, v252, v253
    v_cvt_pk_bf16_f32 v181, v254, v255
    v_lshlrev_b32 v252, 16, v182
    v_and_b32 v253, s50, v182
    v_lshlrev_b32 v254, 16, v183
    v_pk_mul_f32 v[252:253], v[252:253], s[24:25] op_sel_hi:[1,0]
    v_and_b32 v255, s50, v183
    v_pk_mul_f32 v[254:255], v[254:255], s[24:25] op_sel_hi:[1,0]
    v_cvt_pk_bf16_f32 v182, v252, v253
    v_cvt_pk_bf16_f32 v183, v254, v255
    v_lshlrev_b32 v252, 16, v184
    v_and_b32 v253, s50, v184
    v_lshlrev_b32 v254, 16, v185
    v_pk_mul_f32 v[252:253], v[252:253], s[24:25] op_sel_hi:[1,0]
    v_and_b32 v255, s50, v185
    v_pk_mul_f32 v[254:255], v[254:255], s[24:25] op_sel_hi:[1,0]
    v_cvt_pk_bf16_f32 v184, v252, v253
    v_cvt_pk_bf16_f32 v185, v254, v255
    v_lshlrev_b32 v252, 16, v186
    v_and_b32 v253, s50, v186
    v_lshlrev_b32 v254, 16, v187
    v_pk_mul_f32 v[252:253], v[252:253], s[24:25] op_sel_hi:[1,0]
    v_and_b32 v255, s50, v187
    v_pk_mul_f32 v[254:255], v[254:255], s[24:25] op_sel_hi:[1,0]
    v_cvt_pk_bf16_f32 v186, v252, v253
    v_cvt_pk_bf16_f32 v187, v254, v255
    s_nop 1
    v_mfma_f32_16x16x32_bf16 v[24:27], a[192:195], v[172:175], v[4:7]
    v_add_f32 v8, v8, v28
    v_mfma_f32_16x16x32_bf16 v[24:27], a[196:199], v[176:179], v[24:27]
    v_exp_f32 v29, v29
    v_mfma_f32_16x16x32_bf16 v[24:27], a[200:203], v[180:183], v[24:27]
    v_add_f32 v8, v8, v29
    v_cvt_pk_bf16_f32 v38, v28, v29
    v_mfma_f32_16x16x32_bf16 v[24:27], a[204:207], v[184:187], v[24:27]
    v_exp_f32 v30, v30
    v_mfma_f32_16x16x32_bf16 v[32:35], a[208:211], v[172:175], v[4:7]
    v_add_f32 v8, v8, v30
    v_mfma_f32_16x16x32_bf16 v[32:35], a[212:215], v[176:179], v[32:35]
    v_exp_f32 v31, v31
    v_mfma_f32_16x16x32_bf16 v[32:35], a[216:219], v[180:183], v[32:35]
    v_add_f32 v8, v8, v31
    v_cvt_pk_bf16_f32 v39, v30, v31
    v_mfma_f32_16x16x32_bf16 v[32:35], a[220:223], v[184:187], v[32:35]
    v_exp_f32 v24, v24
    v_mfma_f32_16x16x32_bf16 a[0:3], a[224:227], v[36:39], 0
    v_add_f32 v9, v9, v24
    v_mfma_f32_16x16x32_bf16 a[4:7], a[228:231], v[36:39], 0
    v_exp_f32 v25, v25
    v_mfma_f32_16x16x32_bf16 a[8:11], a[232:235], v[36:39], 0
    v_add_f32 v9, v9, v25
    v_cvt_pk_bf16_f32 v40, v24, v25
    v_mfma_f32_16x16x32_bf16 a[12:15], a[236:239], v[36:39], 0
    v_exp_f32 v26, v26
    v_mfma_f32_16x16x32_bf16 a[16:19], a[240:243], v[36:39], 0
    v_add_f32 v9, v9, v26
    v_mfma_f32_16x16x32_bf16 a[20:23], a[244:247], v[36:39], 0
    v_exp_f32 v27, v27
    v_mfma_f32_16x16x32_bf16 a[24:27], a[248:251], v[36:39], 0
    v_add_f32 v9, v9, v27
    v_cvt_pk_bf16_f32 v41, v26, v27
    v_mfma_f32_16x16x32_bf16 a[28:31], a[252:255], v[36:39], 0
    v_exp_f32 v32, v32
    s_nop 0
    s_waitcnt vmcnt(4)
    s_nop 0
    s_add_u32 s36, s25, 12288
    buffer_load_dwordx4 v[108:111], v19, s[8:11], s36 offen offset:0 nt
    buffer_load_dwordx4 v[112:115], v19, s[8:11], s36 offen offset:64 nt
    buffer_load_dwordx4 v[116:119], v19, s[8:11], s36 offen offset:128 nt
    buffer_load_dwordx4 v[120:123], v19, s[8:11], s36 offen offset:192 nt
    v_lshlrev_b32 v252, 16, v188
    v_and_b32 v253, s50, v188
    v_lshlrev_b32 v254, 16, v189
    v_pk_mul_f32 v[252:253], v[252:253], s[24:25] op_sel_hi:[1,0]
    v_and_b32 v255, s50, v189
    v_pk_mul_f32 v[254:255], v[254:255], s[24:25] op_sel_hi:[1,0]
    v_cvt_pk_bf16_f32 v188, v252, v253
    v_cvt_pk_bf16_f32 v189, v254, v255
    v_lshlrev_b32 v252, 16, v190
    v_and_b32 v253, s50, v190
    v_lshlrev_b32 v254, 16, v191
    v_pk_mul_f32 v[252:253], v[252:253], s[24:25] op_sel_hi:[1,0]
    v_and_b32 v255, s50, v191
    v_pk_mul_f32 v[254:255], v[254:255], s[24:25] op_sel_hi:[1,0]
    v_cvt_pk_bf16_f32 v190, v252, v253
    v_cvt_pk_bf16_f32 v191, v254, v255
    v_lshlrev_b32 v252, 16, v192
    v_and_b32 v253, s50, v192
    v_lshlrev_b32 v254, 16, v193
    v_pk_mul_f32 v[252:253], v[252:253], s[24:25] op_sel_hi:[1,0]
    v_and_b32 v255, s50, v193
    v_pk_mul_f32 v[254:255], v[254:255], s[24:25] op_sel_hi:[1,0]
    v_cvt_pk_bf16_f32 v192, v252, v253
    v_cvt_pk_bf16_f32 v193, v254, v255
    v_lshlrev_b32 v252, 16, v194
    v_and_b32 v253, s50, v194
    v_lshlrev_b32 v254, 16, v195
    v_pk_mul_f32 v[252:253], v[252:253], s[24:25] op_sel_hi:[1,0]
    v_and_b32 v255, s50, v195
    v_pk_mul_f32 v[254:255], v[254:255], s[24:25] op_sel_hi:[1,0]
    v_cvt_pk_bf16_f32 v194, v252, v253
    v_cvt_pk_bf16_f32 v195, v254, v255
    v_lshlrev_b32 v252, 16, v196
    v_and_b32 v253, s50, v196
    v_lshlrev_b32 v254, 16, v197
    v_pk_mul_f32 v[252:253], v[252:253], s[24:25] op_sel_hi:[1,0]
    v_and_b32 v255, s50, v197
    v_pk_mul_f32 v[254:255], v[254:255], s[24:25] op_sel_hi:[1,0]
    v_cvt_pk_bf16_f32 v196, v252, v253
    v_cvt_pk_bf16_f32 v197, v254, v255
    v_lshlrev_b32 v252, 16, v198
    v_and_b32 v253, s50, v198
    v_lshlrev_b32 v254, 16, v199
    v_pk_mul_f32 v[252:253], v[252:253], s[24:25] op_sel_hi:[1,0]
    v_and_b32 v255, s50, v199
    v_pk_mul_f32 v[254:255], v[254:255], s[24:25] op_sel_hi:[1,0]
    v_cvt_pk_bf16_f32 v198, v252, v253
    v_cvt_pk_bf16_f32 v199, v254, v255
    v_lshlrev_b32 v252, 16, v200
    v_and_b32 v253, s50, v200
    v_lshlrev_b32 v254, 16, v201
    v_pk_mul_f32 v[252:253], v[252:253], s[24:25] op_sel_hi:[1,0]
    v_and_b32 v255, s50, v201
    v_pk_mul_f32 v[254:255], v[254:255], s[24:25] op_sel_hi:[1,0]
    v_cvt_pk_bf16_f32 v200, v252, v253
    v_cvt_pk_bf16_f32 v201, v254, v255
    v_lshlrev_b32 v252, 16, v202
    v_and_b32 v253, s50, v202
    v_lshlrev_b32 v254, 16, v203
    v_pk_mul_f32 v[252:253], v[252:253], s[24:25] op_sel_hi:[1,0]
    v_and_b32 v255, s50, v203
    v_pk_mul_f32 v[254:255], v[254:255], s[24:25] op_sel_hi:[1,0]
    v_cvt_pk_bf16_f32 v202, v252, v253
    v_cvt_pk_bf16_f32 v203, v254, v255
    s_nop 1
    v_mfma_f32_16x16x32_bf16 v[20:23], a[192:195], v[188:191], v[4:7]
    v_add_f32 v9, v9, v32
    v_mfma_f32_16x16x32_bf16 v[20:23], a[196:199], v[192:195], v[20:23]
    v_exp_f32 v33, v33
    v_mfma_f32_16x16x32_bf16 v[20:23], a[200:203], v[196:199], v[20:23]
    v_add_f32 v9, v9, v33
    v_cvt_pk_bf16_f32 v42, v32, v33
    v_mfma_f32_16x16x32_bf16 v[20:23], a[204:207], v[200:203], v[20:23]
    v_exp_f32 v34, v34
    v_mfma_f32_16x16x32_bf16 v[28:31], a[208:211], v[188:191], v[4:7]
    v_add_f32 v9, v9, v34
    v_mfma_f32_16x16x32_bf16 v[28:31], a[212:215], v[192:195], v[28:31]
    v_exp_f32 v35, v35
    v_mfma_f32_16x16x32_bf16 v[28:31], a[216:219], v[196:199], v[28:31]
    v_add_f32 v9, v9, v35
    v_cvt_pk_bf16_f32 v43, v34, v35
    v_mfma_f32_16x16x32_bf16 v[28:31], a[220:223], v[200:203], v[28:31]
    v_exp_f32 v20, v20
    s_nop 0
    s_waitcnt vmcnt(4)
    s_nop 0
    s_lshl_b32 s37, s4, 9
    s_add_u32 s37, s37, 16384
    s_add_u32 m0, s35, 8448
    s_nop 0
    buffer_load_dwordx4 v3, s[12:15], s37 offen nt lds
    s_add_u32 m0, s35, 12544
    s_nop 0
    buffer_load_dwordx4 v3, s[12:15], s37 offen offset:128 nt lds
    s_add_u32 m0, s35, 42240
    s_nop 0
    buffer_load_dwordx4 v3, s[16:19], s37 offen nt lds
    s_add_u32 m0, s35, 46336
    s_nop 0
    buffer_load_dwordx4 v3, s[16:19], s37 offen offset:128 nt lds
    s_barrier
    v_mfma_f32_16x16x32_bf16 a[32:35], a[224:227], v[40:43], 0
    ds_read_b128 a[192:195], v0 offset:0
    ds_read_b128 a[196:199], v0 offset:64
    ds_read_b128 a[212:215], v0 offset:576
    v_mfma_f32_16x16x32_bf16 a[36:39], a[228:231], v[40:43], 0
    ds_read_b128 a[216:219], v0 offset:4736
    v_exp_f32 v21, v21
    v_mfma_f32_16x16x32_bf16 a[40:43], a[232:235], v[40:43], 0
    ds_read_b128 a[200:203], v0 offset:4224
    ds_read_b128 a[204:207], v0 offset:4288
    ds_read_b128 a[208:211], v0 offset:512
    v_mfma_f32_16x16x32_bf16 a[44:47], a[236:239], v[40:43], 0
    ds_read_b128 a[220:223], v0 offset:4800
    v_exp_f32 v22, v22
    v_mfma_f32_16x16x32_bf16 a[48:51], a[240:243], v[40:43], 0
    v_add_f32 v10, v10, v22
    v_cvt_pk_bf16_f32 v36, v20, v21
    v_mfma_f32_16x16x32_bf16 a[52:55], a[244:247], v[40:43], 0
    v_exp_f32 v23, v23
    v_mfma_f32_16x16x32_bf16 a[56:59], a[248:251], v[40:43], 0
    v_add_f32 v10, v10, v20
    v_cvt_pk_bf16_f32 v37, v22, v23
    v_mfma_f32_16x16x32_bf16 a[60:63], a[252:255], v[40:43], 0
    s_waitcnt lgkmcnt(7)
    v_exp_f32 v28, v28
    v_mfma_f32_16x16x32_bf16 v[24:27], a[192:195], v[156:159], v[4:7]
    s_waitcnt lgkmcnt(6)
    v_add_f32 v10, v10, v21
    v_add_f32 v10, v10, v23
    v_mfma_f32_16x16x32_bf16 v[24:27], a[196:199], v[160:163], v[24:27]
    s_waitcnt lgkmcnt(3)
    v_exp_f32 v29, v29
    v_mfma_f32_16x16x32_bf16 v[24:27], a[200:203], v[164:167], v[24:27]
    s_waitcnt lgkmcnt(2)
    v_add_f32 v10, v10, v28
    v_cvt_pk_bf16_f32 v38, v28, v29
    v_mfma_f32_16x16x32_bf16 v[24:27], a[204:207], v[168:171], v[24:27]
    s_waitcnt lgkmcnt(1)
    v_exp_f32 v30, v30
    v_mfma_f32_16x16x32_bf16 v[32:35], a[208:211], v[156:159], v[4:7]
    v_add_f32 v10, v10, v29
    v_add_f32 v10, v10, v30
    v_mfma_f32_16x16x32_bf16 v[32:35], a[212:215], v[160:163], v[32:35]
    v_exp_f32 v31, v31
    v_mfma_f32_16x16x32_bf16 v[32:35], a[216:219], v[164:167], v[32:35]
    s_waitcnt lgkmcnt(0)
    v_add_f32 v10, v10, v31
    v_cvt_pk_bf16_f32 v39, v30, v31
    v_mfma_f32_16x16x32_bf16 v[32:35], a[220:223], v[168:171], v[32:35]
    v_exp_f32 v24, v24
    v_mfma_f32_16x16x32_bf16 a[64:67], a[224:227], v[36:39], 0
    ds_read_b64_tr_b16 a[224:225], v1 offset:0
    ds_read_b64_tr_b16 a[226:227], v1 offset:512
    v_mfma_f32_16x16x32_bf16 a[68:71], a[228:231], v[36:39], 0
    ds_read_b64_tr_b16 a[230:231], v1 offset:544
    v_exp_f32 v25, v25
    v_mfma_f32_16x16x32_bf16 a[72:75], a[232:235], v[36:39], 0
    ds_read_b64_tr_b16 a[228:229], v1 offset:32
    ds_read_b64_tr_b16 a[232:233], v1 offset:64
    ds_read_b64_tr_b16 a[234:235], v1 offset:576
    v_mfma_f32_16x16x32_bf16 a[76:79], a[236:239], v[36:39], 0
    ds_read_b64_tr_b16 a[236:237], v1 offset:96
    v_exp_f32 v26, v26
    v_mfma_f32_16x16x32_bf16 a[80:83], a[240:243], v[36:39], 0
    ds_read_b64_tr_b16 a[238:239], v1 offset:608
    ds_read_b64_tr_b16 a[240:241], v1 offset:4224
    ds_read_b64_tr_b16 a[242:243], v1 offset:4736
    v_mfma_f32_16x16x32_bf16 a[84:87], a[244:247], v[36:39], 0
    ds_read_b64_tr_b16 a[246:247], v1 offset:4768
    v_exp_f32 v27, v27
    v_mfma_f32_16x16x32_bf16 a[88:91], a[248:251], v[36:39], 0
    ds_read_b64_tr_b16 a[244:245], v1 offset:4256
    ds_read_b64_tr_b16 a[248:249], v1 offset:4288
    ds_read_b64_tr_b16 a[250:251], v1 offset:4800
    v_mfma_f32_16x16x32_bf16 a[92:95], a[252:255], v[36:39], 0
    v_exp_f32 v32, v32
    v_mfma_f32_16x16x32_bf16 v[20:23], a[192:195], v[172:175], v[4:7]
    ds_read_b64_tr_b16 a[252:253], v1 offset:4320
    ds_read_b64_tr_b16 a[254:255], v1 offset:4832
    v_mfma_f32_16x16x32_bf16 v[20:23], a[196:199], v[176:179], v[20:23]
    v_exp_f32 v33, v33
    v_mfma_f32_16x16x32_bf16 v[20:23], a[200:203], v[180:183], v[20:23]
    v_cvt_pk_bf16_f32 v40, v24, v25
    v_cvt_pk_bf16_f32 v42, v32, v33
    v_mfma_f32_16x16x32_bf16 v[20:23], a[204:207], v[184:187], v[20:23]
    v_exp_f32 v34, v34
    v_mfma_f32_16x16x32_bf16 v[28:31], a[208:211], v[172:175], v[4:7]
    v_add_f32 v8, v8, v34
    v_cvt_pk_bf16_f32 v41, v26, v27
    v_mfma_f32_16x16x32_bf16 v[28:31], a[212:215], v[176:179], v[28:31]
    v_exp_f32 v35, v35
    v_mfma_f32_16x16x32_bf16 v[28:31], a[216:219], v[180:183], v[28:31]
    v_add_f32 v8, v8, v32
    v_cvt_pk_bf16_f32 v43, v34, v35
    v_mfma_f32_16x16x32_bf16 v[28:31], a[220:223], v[184:187], v[28:31]
    s_waitcnt lgkmcnt(14)
    v_exp_f32 v20, v20
    v_mfma_f32_16x16x32_bf16 a[0:3], a[224:227], v[40:43], a[0:3]
    s_waitcnt lgkmcnt(12)
    v_add_f32 v8, v8, v26
    v_add_f32 v8, v8, v33
    v_mfma_f32_16x16x32_bf16 a[4:7], a[228:231], v[40:43], a[4:7]
    s_waitcnt lgkmcnt(10)
    v_exp_f32 v21, v21
    v_mfma_f32_16x16x32_bf16 a[8:11], a[232:235], v[40:43], a[8:11]
    s_waitcnt lgkmcnt(8)
    v_add_f32 v8, v8, v24
    v_cvt_pk_bf16_f32 v36, v20, v21
    v_mfma_f32_16x16x32_bf16 a[12:15], a[236:239], v[40:43], a[12:15]
    s_waitcnt lgkmcnt(6)
    v_exp_f32 v22, v22
    v_mfma_f32_16x16x32_bf16 a[16:19], a[240:243], v[40:43], a[16:19]
    s_waitcnt lgkmcnt(4)
    v_add_f32 v8, v8, v25
    v_add_f32 v8, v8, v27
    v_mfma_f32_16x16x32_bf16 a[20:23], a[244:247], v[40:43], a[20:23]
    s_waitcnt lgkmcnt(2)
    v_exp_f32 v23, v23
    v_mfma_f32_16x16x32_bf16 a[24:27], a[248:251], v[40:43], a[24:27]
    s_waitcnt lgkmcnt(0)
    v_add_f32 v9, v9, v22
    v_cvt_pk_bf16_f32 v37, v22, v23
    v_mfma_f32_16x16x32_bf16 a[28:31], a[252:255], v[40:43], a[28:31]
    v_exp_f32 v28, v28
    v_mfma_f32_16x16x32_bf16 v[24:27], a[192:195], v[188:191], v[4:7]
    v_add_f32 v8, v8, v35
    v_add_f32 v9, v9, v28
    v_mfma_f32_16x16x32_bf16 v[24:27], a[196:199], v[192:195], v[24:27]
    v_exp_f32 v29, v29
    v_mfma_f32_16x16x32_bf16 v[24:27], a[200:203], v[196:199], v[24:27]
    v_add_f32 v9, v9, v20
    v_cvt_pk_bf16_f32 v38, v28, v29
    v_mfma_f32_16x16x32_bf16 v[24:27], a[204:207], v[200:203], v[24:27]
    v_exp_f32 v30, v30
    v_mfma_f32_16x16x32_bf16 v[32:35], a[208:211], v[188:191], v[4:7]
    v_add_f32 v9, v9, v23
    v_add_f32 v9, v9, v29
    v_mfma_f32_16x16x32_bf16 v[32:35], a[212:215], v[192:195], v[32:35]
    v_exp_f32 v31, v31
    v_mfma_f32_16x16x32_bf16 v[32:35], a[216:219], v[196:199], v[32:35]
    v_add_f32 v9, v9, v31
    v_cvt_pk_bf16_f32 v39, v30, v31
    v_mfma_f32_16x16x32_bf16 v[32:35], a[220:223], v[200:203], v[32:35]
    v_exp_f32 v24, v24
    v_mfma_f32_16x16x32_bf16 a[32:35], a[224:227], v[36:39], a[32:35]
    v_add_f32 v9, v9, v21
    v_add_f32 v9, v9, v30
    v_mfma_f32_16x16x32_bf16 a[36:39], a[228:231], v[36:39], a[36:39]
    v_exp_f32 v25, v25
    v_mfma_f32_16x16x32_bf16 a[40:43], a[232:235], v[36:39], a[40:43]
    v_add_f32 v10, v10, v24
    v_cvt_pk_bf16_f32 v40, v24, v25
    v_mfma_f32_16x16x32_bf16 a[44:47], a[236:239], v[36:39], a[44:47]
    v_exp_f32 v26, v26
    v_mfma_f32_16x16x32_bf16 a[48:51], a[240:243], v[36:39], a[48:51]
    v_add_f32 v10, v10, v25
    v_add_f32 v10, v10, v26
    v_mfma_f32_16x16x32_bf16 a[52:55], a[244:247], v[36:39], a[52:55]
    v_exp_f32 v27, v27
    v_mfma_f32_16x16x32_bf16 a[56:59], a[248:251], v[36:39], a[56:59]
    v_add_f32 v10, v10, v27
    v_cvt_pk_bf16_f32 v41, v26, v27
    v_mfma_f32_16x16x32_bf16 a[60:63], a[252:255], v[36:39], a[60:63]
    v_exp_f32 v32, v32
    s_nop 0
    s_waitcnt vmcnt(4)
    s_nop 0
    s_add_u32 s36, s25, 16384
    buffer_load_dwordx4 v[204:207], v19, s[8:11], s36 offen offset:0 nt
    buffer_load_dwordx4 v[208:211], v19, s[8:11], s36 offen offset:64 nt
    buffer_load_dwordx4 v[212:215], v19, s[8:11], s36 offen offset:128 nt
    buffer_load_dwordx4 v[216:219], v19, s[8:11], s36 offen offset:192 nt
    v_lshlrev_b32 v252, 16, v108
    v_and_b32 v253, s50, v108
    v_lshlrev_b32 v254, 16, v109
    v_pk_mul_f32 v[252:253], v[252:253], s[24:25] op_sel_hi:[1,0]
    v_and_b32 v255, s50, v109
    v_pk_mul_f32 v[254:255], v[254:255], s[24:25] op_sel_hi:[1,0]
    v_cvt_pk_bf16_f32 v108, v252, v253
    v_cvt_pk_bf16_f32 v109, v254, v255
    v_lshlrev_b32 v252, 16, v110
    v_and_b32 v253, s50, v110
    v_lshlrev_b32 v254, 16, v111
    v_pk_mul_f32 v[252:253], v[252:253], s[24:25] op_sel_hi:[1,0]
    v_and_b32 v255, s50, v111
    v_pk_mul_f32 v[254:255], v[254:255], s[24:25] op_sel_hi:[1,0]
    v_cvt_pk_bf16_f32 v110, v252, v253
    v_cvt_pk_bf16_f32 v111, v254, v255
    v_lshlrev_b32 v252, 16, v112
    v_and_b32 v253, s50, v112
    v_lshlrev_b32 v254, 16, v113
    v_pk_mul_f32 v[252:253], v[252:253], s[24:25] op_sel_hi:[1,0]
    v_and_b32 v255, s50, v113
    v_pk_mul_f32 v[254:255], v[254:255], s[24:25] op_sel_hi:[1,0]
    v_cvt_pk_bf16_f32 v112, v252, v253
    v_cvt_pk_bf16_f32 v113, v254, v255
    v_lshlrev_b32 v252, 16, v114
    v_and_b32 v253, s50, v114
    v_lshlrev_b32 v254, 16, v115
    v_pk_mul_f32 v[252:253], v[252:253], s[24:25] op_sel_hi:[1,0]
    v_and_b32 v255, s50, v115
    v_pk_mul_f32 v[254:255], v[254:255], s[24:25] op_sel_hi:[1,0]
    v_cvt_pk_bf16_f32 v114, v252, v253
    v_cvt_pk_bf16_f32 v115, v254, v255
    v_lshlrev_b32 v252, 16, v116
    v_and_b32 v253, s50, v116
    v_lshlrev_b32 v254, 16, v117
    v_pk_mul_f32 v[252:253], v[252:253], s[24:25] op_sel_hi:[1,0]
    v_and_b32 v255, s50, v117
    v_pk_mul_f32 v[254:255], v[254:255], s[24:25] op_sel_hi:[1,0]
    v_cvt_pk_bf16_f32 v116, v252, v253
    v_cvt_pk_bf16_f32 v117, v254, v255
    v_lshlrev_b32 v252, 16, v118
    v_and_b32 v253, s50, v118
    v_lshlrev_b32 v254, 16, v119
    v_pk_mul_f32 v[252:253], v[252:253], s[24:25] op_sel_hi:[1,0]
    v_and_b32 v255, s50, v119
    v_pk_mul_f32 v[254:255], v[254:255], s[24:25] op_sel_hi:[1,0]
    v_cvt_pk_bf16_f32 v118, v252, v253
    v_cvt_pk_bf16_f32 v119, v254, v255
    v_lshlrev_b32 v252, 16, v120
    v_and_b32 v253, s50, v120
    v_lshlrev_b32 v254, 16, v121
    v_pk_mul_f32 v[252:253], v[252:253], s[24:25] op_sel_hi:[1,0]
    v_and_b32 v255, s50, v121
    v_pk_mul_f32 v[254:255], v[254:255], s[24:25] op_sel_hi:[1,0]
    v_cvt_pk_bf16_f32 v120, v252, v253
    v_cvt_pk_bf16_f32 v121, v254, v255
    v_lshlrev_b32 v252, 16, v122
    v_and_b32 v253, s50, v122
    v_lshlrev_b32 v254, 16, v123
    v_pk_mul_f32 v[252:253], v[252:253], s[24:25] op_sel_hi:[1,0]
    v_and_b32 v255, s50, v123
    v_pk_mul_f32 v[254:255], v[254:255], s[24:25] op_sel_hi:[1,0]
    v_cvt_pk_bf16_f32 v122, v252, v253
    v_cvt_pk_bf16_f32 v123, v254, v255
    ds_write_b128 v2, v[108:111] offset:0
    ds_write_b128 v2, v[112:115] offset:64
    ds_write_b128 v2, v[116:119] offset:4224
    ds_write_b128 v2, v[120:123] offset:4288
    s_nop 1
    v_mfma_f32_16x16x32_bf16 v[20:23], a[192:195], v[108:111], v[4:7]
    ds_read_b128 a[192:195], v0 offset:25344
    v_add_f32 v10, v10, v32
    v_mfma_f32_16x16x32_bf16 v[20:23], a[196:199], v[112:115], v[20:23]
    ds_read_b128 a[196:199], v0 offset:25408
    v_exp_f32 v33, v33
    v_mfma_f32_16x16x32_bf16 v[20:23], a[200:203], v[116:119], v[20:23]
    ds_read_b128 a[200:203], v0 offset:29568
    v_cvt_pk_bf16_f32 v42, v32, v33
    v_mfma_f32_16x16x32_bf16 v[20:23], a[204:207], v[120:123], v[20:23]
    v_exp_f32 v34, v34
    v_mfma_f32_16x16x32_bf16 v[28:31], a[208:211], v[108:111], v[4:7]
    ds_read_b128 a[204:207], v0 offset:29632
    ds_read_b128 a[208:211], v0 offset:25856
    v_mfma_f32_16x16x32_bf16 v[28:31], a[212:215], v[112:115], v[28:31]
    ds_read_b128 a[212:215], v0 offset:25920
    v_exp_f32 v35, v35
    v_mfma_f32_16x16x32_bf16 v[28:31], a[216:219], v[116:119], v[28:31]
    ds_read_b128 a[216:219], v0 offset:30080
    v_cvt_pk_bf16_f32 v43, v34, v35
    v_mfma_f32_16x16x32_bf16 v[28:31], a[220:223], v[120:123], v[28:31]
    v_exp_f32 v20, v20
    v_mfma_f32_16x16x32_bf16 a[64:67], a[224:227], v[40:43], a[64:67]
    ds_read_b128 a[220:223], v0 offset:30144
    v_add_f32 v10, v10, v34
    v_mfma_f32_16x16x32_bf16 a[68:71], a[228:231], v[40:43], a[68:71]
    v_exp_f32 v21, v21
    v_mfma_f32_16x16x32_bf16 a[72:75], a[232:235], v[40:43], a[72:75]
    v_add_f32 v10, v10, v35
    v_cvt_pk_bf16_f32 v36, v20, v21
    v_mfma_f32_16x16x32_bf16 a[76:79], a[236:239], v[40:43], a[76:79]
    v_exp_f32 v22, v22
    v_mfma_f32_16x16x32_bf16 a[80:83], a[240:243], v[40:43], a[80:83]
    v_add_f32 v10, v10, v33
    v_add_f32 v11, v11, v21
    v_mfma_f32_16x16x32_bf16 a[84:87], a[244:247], v[40:43], a[84:87]
    v_exp_f32 v23, v23
    v_mfma_f32_16x16x32_bf16 a[88:91], a[248:251], v[40:43], a[88:91]
    v_add_f32 v11, v11, v20
    v_cvt_pk_bf16_f32 v37, v22, v23
    v_mfma_f32_16x16x32_bf16 a[92:95], a[252:255], v[40:43], a[92:95]
    s_waitcnt lgkmcnt(7)
    v_exp_f32 v28, v28
    v_mfma_f32_16x16x32_bf16 v[24:27], a[192:195], v[108:111], v[4:7]
    s_waitcnt lgkmcnt(6)
    v_add_f32 v11, v11, v23
    v_add_f32 v11, v11, v28
    v_mfma_f32_16x16x32_bf16 v[24:27], a[196:199], v[112:115], v[24:27]
    s_waitcnt lgkmcnt(5)
    v_exp_f32 v29, v29
    v_mfma_f32_16x16x32_bf16 v[24:27], a[200:203], v[116:119], v[24:27]
    s_waitcnt lgkmcnt(4)
    v_add_f32 v11, v11, v22
    v_cvt_pk_bf16_f32 v38, v28, v29
    v_mfma_f32_16x16x32_bf16 v[24:27], a[204:207], v[120:123], v[24:27]
    s_waitcnt lgkmcnt(3)
    v_exp_f32 v30, v30
    v_mfma_f32_16x16x32_bf16 v[32:35], a[208:211], v[108:111], v[4:7]
    s_waitcnt lgkmcnt(2)
    v_add_f32 v11, v11, v29
    v_add_f32 v11, v11, v30
    v_mfma_f32_16x16x32_bf16 v[32:35], a[212:215], v[112:115], v[32:35]
    s_waitcnt lgkmcnt(1)
    v_exp_f32 v31, v31
    v_mfma_f32_16x16x32_bf16 v[32:35], a[216:219], v[116:119], v[32:35]
    s_waitcnt lgkmcnt(0)
    v_add_f32 v11, v11, v31
    v_cvt_pk_bf16_f32 v39, v30, v31
    v_mfma_f32_16x16x32_bf16 v[32:35], a[220:223], v[120:123], v[32:35]
    v_exp_f32 v24, v24
    s_nop 0
    s_waitcnt vmcnt(4)
    s_nop 0
    s_add_u32 s36, s25, 20480
    buffer_load_dwordx4 v[124:127], v19, s[8:11], s36 offen offset:0 nt
    buffer_load_dwordx4 v[128:131], v19, s[8:11], s36 offen offset:64 nt
    buffer_load_dwordx4 v[132:135], v19, s[8:11], s36 offen offset:128 nt
    buffer_load_dwordx4 v[136:139], v19, s[8:11], s36 offen offset:192 nt
    s_barrier
    v_mfma_f32_16x16x32_bf16 a[96:99], a[224:227], v[36:39], 0
    ds_read_b64_tr_b16 a[226:227], v1 offset:25856
    ds_read_b128 a[192:195], v0 offset:8448
    ds_read_b128 a[196:199], v0 offset:8512
    v_mfma_f32_16x16x32_bf16 a[100:103], a[228:231], v[36:39], 0
    ds_read_b64_tr_b16 a[228:229], v1 offset:25376
    v_exp_f32 v25, v25
    v_mfma_f32_16x16x32_bf16 a[104:107], a[232:235], v[36:39], 0
    ds_read_b128 a[208:211], v0 offset:8960
    ds_read_b128 a[216:219], v0 offset:13184
    ds_read_b128 a[220:223], v0 offset:13248
    v_mfma_f32_16x16x32_bf16 a[108:111], a[236:239], v[36:39], 0
    ds_read_b128 a[200:203], v0 offset:12672
    v_exp_f32 v26, v26
    v_mfma_f32_16x16x32_bf16 a[112:115], a[240:243], v[36:39], 0
    ds_read_b64_tr_b16 a[238:239], v1 offset:25952
    ds_read_b64_tr_b16 a[242:243], v1 offset:30080
    ds_read_b128 a[204:207], v0 offset:12736
    v_mfma_f32_16x16x32_bf16 a[116:119], a[244:247], v[36:39], 0
    ds_read_b128 a[212:215], v0 offset:9024
    v_exp_f32 v27, v27
    v_mfma_f32_16x16x32_bf16 a[120:123], a[248:251], v[36:39], 0
    ds_read_b64_tr_b16 a[224:225], v1 offset:25344
    ds_read_b64_tr_b16 a[248:249], v1 offset:29632
    ds_read_b64_tr_b16 a[250:251], v1 offset:30144
    v_mfma_f32_16x16x32_bf16 a[124:127], a[252:255], v[36:39], 0
    s_waitcnt lgkmcnt(13)
    ds_read_b64_tr_b16 a[230:231], v1 offset:25888
    v_exp_f32 v32, v32
    v_mfma_f32_16x16x32_bf16 v[20:23], a[192:195], v[156:159], v[4:7]
    s_waitcnt lgkmcnt(13)
    ds_read_b64_tr_b16 a[232:233], v1 offset:25408
    ds_read_b64_tr_b16 a[252:253], v1 offset:29664
    ds_read_b64_tr_b16 a[254:255], v1 offset:30176
    v_mfma_f32_16x16x32_bf16 v[20:23], a[196:199], v[160:163], v[20:23]
    s_waitcnt lgkmcnt(11)
    ds_read_b64_tr_b16 a[236:237], v1 offset:25440
    v_exp_f32 v33, v33
    v_mfma_f32_16x16x32_bf16 v[20:23], a[200:203], v[164:167], v[20:23]
    s_waitcnt lgkmcnt(9)
    ds_read_b64_tr_b16 a[234:235], v1 offset:25920
    ds_read_b64_tr_b16 a[244:245], v1 offset:29600
    v_cvt_pk_bf16_f32 v41, v26, v27
    v_mfma_f32_16x16x32_bf16 v[20:23], a[204:207], v[168:171], v[20:23]
    ds_read_b64_tr_b16 a[246:247], v1 offset:30112
    v_exp_f32 v34, v34
    v_mfma_f32_16x16x32_bf16 v[28:31], a[208:211], v[156:159], v[4:7]
    s_waitcnt lgkmcnt(11)
    v_add_f32 v11, v11, v24
    v_cvt_pk_bf16_f32 v40, v24, v25
    v_cvt_pk_bf16_f32 v42, v32, v33
    v_mfma_f32_16x16x32_bf16 v[28:31], a[212:215], v[160:163], v[28:31]
    ds_read_b64_tr_b16 a[240:241], v1 offset:29568
    v_exp_f32 v35, v35
    v_mfma_f32_16x16x32_bf16 v[28:31], a[216:219], v[164:167], v[28:31]
    v_add_f32 v11, v11, v25
    v_add_f32 v11, v11, v26
    v_cvt_pk_bf16_f32 v43, v34, v35
    v_mfma_f32_16x16x32_bf16 v[28:31], a[220:223], v[168:171], v[28:31]
    s_waitcnt lgkmcnt(11)
    v_exp_f32 v20, v20
    v_mfma_f32_16x16x32_bf16 a[96:99], a[224:227], v[40:43], a[96:99]
    s_waitcnt lgkmcnt(8)
    ds_read_b64_tr_b16 a[224:225], v1 offset:8448
    ds_read_b64_tr_b16 a[226:227], v1 offset:8960
    v_add_f32 v11, v11, v27
    v_mfma_f32_16x16x32_bf16 a[100:103], a[228:231], v[40:43], a[100:103]
    s_waitcnt lgkmcnt(5)
    ds_read_b64_tr_b16 a[230:231], v1 offset:8992
    v_exp_f32 v21, v21
    v_mfma_f32_16x16x32_bf16 a[104:107], a[232:235], v[40:43], a[104:107]
    ds_read_b64_tr_b16 a[228:229], v1 offset:8480
    ds_read_b64_tr_b16 a[232:233], v1 offset:8512
    ds_read_b64_tr_b16 a[234:235], v1 offset:9024
    v_mfma_f32_16x16x32_bf16 a[108:111], a[236:239], v[40:43], a[108:111]
    s_waitcnt lgkmcnt(6)
    ds_read_b64_tr_b16 a[238:239], v1 offset:9056
    v_exp_f32 v22, v22
    v_mfma_f32_16x16x32_bf16 a[112:115], a[240:243], v[40:43], a[112:115]
    ds_read_b64_tr_b16 a[236:237], v1 offset:8544
    ds_read_b64_tr_b16 a[240:241], v1 offset:12672
    ds_read_b64_tr_b16 a[242:243], v1 offset:13184
    v_mfma_f32_16x16x32_bf16 a[116:119], a[244:247], v[40:43], a[116:119]
    ds_read_b64_tr_b16 a[244:245], v1 offset:12704
    v_exp_f32 v23, v23
    v_mfma_f32_16x16x32_bf16 a[120:123], a[248:251], v[40:43], a[120:123]
    ds_read_b64_tr_b16 a[246:247], v1 offset:13216
    ds_read_b64_tr_b16 a[248:249], v1 offset:12736
    ds_read_b64_tr_b16 a[250:251], v1 offset:13248
    v_mfma_f32_16x16x32_bf16 a[124:127], a[252:255], v[40:43], a[124:127]
    ds_read_b64_tr_b16 a[252:253], v1 offset:12768
    v_exp_f32 v28, v28
    v_mfma_f32_16x16x32_bf16 v[24:27], a[192:195], v[172:175], v[4:7]
    ds_read_b64_tr_b16 a[254:255], v1 offset:13280
    v_add_f32 v11, v11, v32
    v_cvt_pk_bf16_f32 v37, v22, v23
    v_mfma_f32_16x16x32_bf16 v[24:27], a[196:199], v[176:179], v[24:27]
    v_exp_f32 v29, v29
    v_mfma_f32_16x16x32_bf16 v[24:27], a[200:203], v[180:183], v[24:27]
    v_add_f32 v11, v11, v33
    v_add_f32 v11, v11, v34
    v_add_f32 v11, v11, v35
    v_mfma_f32_16x16x32_bf16 v[24:27], a[204:207], v[184:187], v[24:27]
    v_exp_f32 v30, v30
    v_mfma_f32_16x16x32_bf16 v[32:35], a[208:211], v[172:175], v[4:7]
    v_cvt_pk_bf16_f32 v36, v20, v21
    v_cvt_pk_bf16_f32 v38, v28, v29
    v_mfma_f32_16x16x32_bf16 v[32:35], a[212:215], v[176:179], v[32:35]
    v_exp_f32 v31, v31
    v_mfma_f32_16x16x32_bf16 v[32:35], a[216:219], v[180:183], v[32:35]
    ds_read_b128 v[108:111], v2 offset:0
    v_cvt_pk_bf16_f32 v39, v30, v31
    v_mfma_f32_16x16x32_bf16 v[32:35], a[220:223], v[184:187], v[32:35]
    s_waitcnt lgkmcnt(15)
    ds_read_b128 v[112:115], v2 offset:64
    v_exp_f32 v24, v24
    v_mfma_f32_16x16x32_bf16 a[0:3], a[224:227], v[36:39], a[0:3]
    s_waitcnt lgkmcnt(14)
    ds_read_b128 v[116:119], v2 offset:4224
    v_add_f32 v8, v8, v21
    v_mfma_f32_16x16x32_bf16 a[4:7], a[228:231], v[36:39], a[4:7]
    s_waitcnt lgkmcnt(13)
    v_exp_f32 v25, v25
    v_mfma_f32_16x16x32_bf16 a[8:11], a[232:235], v[36:39], a[8:11]
    s_waitcnt lgkmcnt(11)
    ds_read_b128 v[120:123], v2 offset:4288
    v_cvt_pk_bf16_f32 v40, v24, v25
    v_mfma_f32_16x16x32_bf16 a[12:15], a[236:239], v[36:39], a[12:15]
    s_waitcnt lgkmcnt(10)
    v_exp_f32 v26, v26
    v_mfma_f32_16x16x32_bf16 a[16:19], a[240:243], v[36:39], a[16:19]
    s_waitcnt lgkmcnt(8)
    v_add_f32 v8, v8, v20
    v_add_f32 v8, v8, v23
    v_mfma_f32_16x16x32_bf16 a[20:23], a[244:247], v[36:39], a[20:23]
    s_waitcnt lgkmcnt(6)
    v_exp_f32 v27, v27
    v_mfma_f32_16x16x32_bf16 a[24:27], a[248:251], v[36:39], a[24:27]
    s_waitcnt lgkmcnt(4)
    v_add_f32 v8, v8, v22
    v_cvt_pk_bf16_f32 v41, v26, v27
    v_mfma_f32_16x16x32_bf16 a[28:31], a[252:255], v[36:39], a[28:31]
    v_exp_f32 v32, v32
    v_mfma_f32_16x16x32_bf16 v[20:23], a[192:195], v[188:191], v[4:7]
    v_add_f32 v8, v8, v29
    v_add_f32 v8, v8, v31
    v_mfma_f32_16x16x32_bf16 v[20:23], a[196:199], v[192:195], v[20:23]
    v_exp_f32 v33, v33
    v_mfma_f32_16x16x32_bf16 v[20:23], a[200:203], v[196:199], v[20:23]
    v_add_f32 v8, v8, v28
    v_add_f32 v8, v8, v30
    v_mfma_f32_16x16x32_bf16 v[20:23], a[204:207], v[200:203], v[20:23]
    v_exp_f32 v34, v34
    v_mfma_f32_16x16x32_bf16 v[28:31], a[208:211], v[188:191], v[4:7]
    v_add_f32 v9, v9, v34
    v_cvt_pk_bf16_f32 v42, v32, v33
    v_mfma_f32_16x16x32_bf16 v[28:31], a[212:215], v[192:195], v[28:31]
    v_exp_f32 v35, v35
    v_mfma_f32_16x16x32_bf16 v[28:31], a[216:219], v[196:199], v[28:31]
    v_add_f32 v9, v9, v27
    v_cvt_pk_bf16_f32 v43, v34, v35
    v_mfma_f32_16x16x32_bf16 v[28:31], a[220:223], v[200:203], v[28:31]
    v_exp_f32 v20, v20
    v_mfma_f32_16x16x32_bf16 a[32:35], a[224:227], v[40:43], a[32:35]
    v_add_f32 v9, v9, v26
    v_add_f32 v10, v10, v20
    v_mfma_f32_16x16x32_bf16 a[36:39], a[228:231], v[40:43], a[36:39]
    v_exp_f32 v21, v21
    v_mfma_f32_16x16x32_bf16 a[40:43], a[232:235], v[40:43], a[40:43]
    v_add_f32 v10, v10, v21
    v_cvt_pk_bf16_f32 v36, v20, v21
    v_mfma_f32_16x16x32_bf16 a[44:47], a[236:239], v[40:43], a[44:47]
    v_exp_f32 v22, v22
    v_mfma_f32_16x16x32_bf16 a[48:51], a[240:243], v[40:43], a[48:51]
    v_add_f32 v9, v9, v24
    v_add_f32 v9, v9, v32
    v_mfma_f32_16x16x32_bf16 a[52:55], a[244:247], v[40:43], a[52:55]
    v_exp_f32 v23, v23
    v_mfma_f32_16x16x32_bf16 a[56:59], a[248:251], v[40:43], a[56:59]
    v_add_f32 v9, v9, v25
    v_cvt_pk_bf16_f32 v37, v22, v23
    v_mfma_f32_16x16x32_bf16 a[60:63], a[252:255], v[40:43], a[60:63]
    s_waitcnt lgkmcnt(3)
    v_exp_f32 v28, v28
    v_mfma_f32_16x16x32_bf16 v[24:27], a[192:195], v[108:111], v[4:7]
    s_waitcnt lgkmcnt(2)
    v_add_f32 v9, v9, v35
    v_add_f32 v10, v10, v28
    v_mfma_f32_16x16x32_bf16 v[24:27], a[196:199], v[112:115], v[24:27]
    s_waitcnt lgkmcnt(1)
    v_exp_f32 v29, v29
    v_mfma_f32_16x16x32_bf16 v[24:27], a[200:203], v[116:119], v[24:27]
    s_waitcnt lgkmcnt(0)
    v_add_f32 v9, v9, v33
    v_cvt_pk_bf16_f32 v38, v28, v29
    v_mfma_f32_16x16x32_bf16 v[24:27], a[204:207], v[120:123], v[24:27]
    v_exp_f32 v30, v30
    v_mfma_f32_16x16x32_bf16 v[32:35], a[208:211], v[108:111], v[4:7]
    v_add_f32 v10, v10, v22
    v_add_f32 v10, v10, v30
    v_mfma_f32_16x16x32_bf16 v[32:35], a[212:215], v[112:115], v[32:35]
    v_exp_f32 v31, v31
    v_mfma_f32_16x16x32_bf16 v[32:35], a[216:219], v[116:119], v[32:35]
    v_add_f32 v10, v10, v31
    v_cvt_pk_bf16_f32 v39, v30, v31
    v_mfma_f32_16x16x32_bf16 v[32:35], a[220:223], v[120:123], v[32:35]
    v_exp_f32 v24, v24
    v_mfma_f32_16x16x32_bf16 a[64:67], a[224:227], v[36:39], a[64:67]
    v_add_f32 v10, v10, v23
    v_add_f32 v11, v11, v24
    v_mfma_f32_16x16x32_bf16 a[68:71], a[228:231], v[36:39], a[68:71]
    v_exp_f32 v25, v25
    v_mfma_f32_16x16x32_bf16 a[72:75], a[232:235], v[36:39], a[72:75]
    v_add_f32 v11, v11, v25
    v_cvt_pk_bf16_f32 v40, v24, v25
    v_mfma_f32_16x16x32_bf16 a[76:79], a[236:239], v[36:39], a[76:79]
    v_exp_f32 v26, v26
    v_mfma_f32_16x16x32_bf16 a[80:83], a[240:243], v[36:39], a[80:83]
    v_add_f32 v10, v10, v29
    v_add_f32 v11, v11, v26
    v_mfma_f32_16x16x32_bf16 a[84:87], a[244:247], v[36:39], a[84:87]
    v_exp_f32 v27, v27
    v_mfma_f32_16x16x32_bf16 a[88:91], a[248:251], v[36:39], a[88:91]
    v_add_f32 v11, v11, v27
    v_cvt_pk_bf16_f32 v41, v26, v27
    v_mfma_f32_16x16x32_bf16 a[92:95], a[252:255], v[36:39], a[92:95]
    v_exp_f32 v32, v32
    s_nop 0
    s_waitcnt vmcnt(4)
    s_nop 0
    s_add_u32 s36, s25, 24576
    buffer_load_dwordx4 v[220:223], v19, s[8:11], s36 offen offset:0 nt
    buffer_load_dwordx4 v[224:227], v19, s[8:11], s36 offen offset:64 nt
    buffer_load_dwordx4 v[228:231], v19, s[8:11], s36 offen offset:128 nt
    buffer_load_dwordx4 v[232:235], v19, s[8:11], s36 offen offset:192 nt
    v_lshlrev_b32 v252, 16, v204
    v_and_b32 v253, s50, v204
    v_lshlrev_b32 v254, 16, v205
    v_pk_mul_f32 v[252:253], v[252:253], s[24:25] op_sel_hi:[1,0]
    v_and_b32 v255, s50, v205
    v_pk_mul_f32 v[254:255], v[254:255], s[24:25] op_sel_hi:[1,0]
    v_cvt_pk_bf16_f32 v204, v252, v253
    v_cvt_pk_bf16_f32 v205, v254, v255
    v_lshlrev_b32 v252, 16, v206
    v_and_b32 v253, s50, v206
    v_lshlrev_b32 v254, 16, v207
    v_pk_mul_f32 v[252:253], v[252:253], s[24:25] op_sel_hi:[1,0]
    v_and_b32 v255, s50, v207
    v_pk_mul_f32 v[254:255], v[254:255], s[24:25] op_sel_hi:[1,0]
    v_cvt_pk_bf16_f32 v206, v252, v253
    v_cvt_pk_bf16_f32 v207, v254, v255
    v_lshlrev_b32 v252, 16, v208
    v_and_b32 v253, s50, v208
    v_lshlrev_b32 v254, 16, v209
    v_pk_mul_f32 v[252:253], v[252:253], s[24:25] op_sel_hi:[1,0]
    v_and_b32 v255, s50, v209
    v_pk_mul_f32 v[254:255], v[254:255], s[24:25] op_sel_hi:[1,0]
    v_cvt_pk_bf16_f32 v208, v252, v253
    v_cvt_pk_bf16_f32 v209, v254, v255
    v_lshlrev_b32 v252, 16, v210
    v_and_b32 v253, s50, v210
    v_lshlrev_b32 v254, 16, v211
    v_pk_mul_f32 v[252:253], v[252:253], s[24:25] op_sel_hi:[1,0]
    v_and_b32 v255, s50, v211
    v_pk_mul_f32 v[254:255], v[254:255], s[24:25] op_sel_hi:[1,0]
    v_cvt_pk_bf16_f32 v210, v252, v253
    v_cvt_pk_bf16_f32 v211, v254, v255
    v_lshlrev_b32 v252, 16, v212
    v_and_b32 v253, s50, v212
    v_lshlrev_b32 v254, 16, v213
    v_pk_mul_f32 v[252:253], v[252:253], s[24:25] op_sel_hi:[1,0]
    v_and_b32 v255, s50, v213
    v_pk_mul_f32 v[254:255], v[254:255], s[24:25] op_sel_hi:[1,0]
    v_cvt_pk_bf16_f32 v212, v252, v253
    v_cvt_pk_bf16_f32 v213, v254, v255
    v_lshlrev_b32 v252, 16, v214
    v_and_b32 v253, s50, v214
    v_lshlrev_b32 v254, 16, v215
    v_pk_mul_f32 v[252:253], v[252:253], s[24:25] op_sel_hi:[1,0]
    v_and_b32 v255, s50, v215
    v_pk_mul_f32 v[254:255], v[254:255], s[24:25] op_sel_hi:[1,0]
    v_cvt_pk_bf16_f32 v214, v252, v253
    v_cvt_pk_bf16_f32 v215, v254, v255
    v_lshlrev_b32 v252, 16, v216
    v_and_b32 v253, s50, v216
    v_lshlrev_b32 v254, 16, v217
    v_pk_mul_f32 v[252:253], v[252:253], s[24:25] op_sel_hi:[1,0]
    v_and_b32 v255, s50, v217
    v_pk_mul_f32 v[254:255], v[254:255], s[24:25] op_sel_hi:[1,0]
    v_cvt_pk_bf16_f32 v216, v252, v253
    v_cvt_pk_bf16_f32 v217, v254, v255
    v_lshlrev_b32 v252, 16, v218
    v_and_b32 v253, s50, v218
    v_lshlrev_b32 v254, 16, v219
    v_pk_mul_f32 v[252:253], v[252:253], s[24:25] op_sel_hi:[1,0]
    v_and_b32 v255, s50, v219
    v_pk_mul_f32 v[254:255], v[254:255], s[24:25] op_sel_hi:[1,0]
    v_cvt_pk_bf16_f32 v218, v252, v253
    v_cvt_pk_bf16_f32 v219, v254, v255
    s_nop 1
    v_mfma_f32_16x16x32_bf16 v[20:23], a[192:195], v[204:207], v[4:7]
    ds_read_b128 a[192:195], v0 offset:25344
    v_add_f32 v11, v11, v32
    v_mfma_f32_16x16x32_bf16 v[20:23], a[196:199], v[208:211], v[20:23]
    ds_read_b128 a[196:199], v0 offset:25408
    v_exp_f32 v33, v33
    v_mfma_f32_16x16x32_bf16 v[20:23], a[200:203], v[212:215], v[20:23]
    ds_read_b128 a[200:203], v0 offset:29568
    v_cvt_pk_bf16_f32 v42, v32, v33
    v_mfma_f32_16x16x32_bf16 v[20:23], a[204:207], v[216:219], v[20:23]
    v_exp_f32 v34, v34
    v_mfma_f32_16x16x32_bf16 v[28:31], a[208:211], v[204:207], v[4:7]
    ds_read_b128 a[204:207], v0 offset:29632
    ds_read_b128 a[208:211], v0 offset:25856
    v_mfma_f32_16x16x32_bf16 v[28:31], a[212:215], v[208:211], v[28:31]
    ds_read_b128 a[212:215], v0 offset:25920
    v_exp_f32 v35, v35
    v_mfma_f32_16x16x32_bf16 v[28:31], a[216:219], v[212:215], v[28:31]
    ds_read_b128 a[216:219], v0 offset:30080
    v_cvt_pk_bf16_f32 v43, v34, v35
    v_mfma_f32_16x16x32_bf16 v[28:31], a[220:223], v[216:219], v[28:31]
    v_exp_f32 v20, v20
    v_mfma_f32_16x16x32_bf16 a[96:99], a[224:227], v[40:43], a[96:99]
    ds_read_b128 a[220:223], v0 offset:30144
    v_add_f32 v11, v11, v35
    v_mfma_f32_16x16x32_bf16 a[100:103], a[228:231], v[40:43], a[100:103]
    v_exp_f32 v21, v21
    v_mfma_f32_16x16x32_bf16 a[104:107], a[232:235], v[40:43], a[104:107]
    v_add_f32 v11, v11, v34
    v_cvt_pk_bf16_f32 v36, v20, v21
    v_mfma_f32_16x16x32_bf16 a[108:111], a[236:239], v[40:43], a[108:111]
    v_exp_f32 v22, v22
    v_mfma_f32_16x16x32_bf16 a[112:115], a[240:243], v[40:43], a[112:115]
    v_add_f32 v11, v11, v33
    v_add_f32 v12, v12, v20
    v_mfma_f32_16x16x32_bf16 a[116:119], a[244:247], v[40:43], a[116:119]
    v_exp_f32 v23, v23
    v_mfma_f32_16x16x32_bf16 a[120:123], a[248:251], v[40:43], a[120:123]
    v_add_f32 v12, v12, v22
    v_cvt_pk_bf16_f32 v37, v22, v23
    v_mfma_f32_16x16x32_bf16 a[124:127], a[252:255], v[40:43], a[124:127]
    s_waitcnt lgkmcnt(7)
    v_exp_f32 v28, v28
    v_mfma_f32_16x16x32_bf16 v[24:27], a[192:195], v[204:207], v[4:7]
    s_waitcnt lgkmcnt(6)
    v_add_f32 v12, v12, v21
    v_add_f32 v12, v12, v23
    v_mfma_f32_16x16x32_bf16 v[24:27], a[196:199], v[208:211], v[24:27]
    s_waitcnt lgkmcnt(5)
    v_exp_f32 v29, v29
    v_mfma_f32_16x16x32_bf16 v[24:27], a[200:203], v[212:215], v[24:27]
    s_waitcnt lgkmcnt(4)
    v_add_f32 v12, v12, v28
    v_cvt_pk_bf16_f32 v38, v28, v29
    v_mfma_f32_16x16x32_bf16 v[24:27], a[204:207], v[216:219], v[24:27]
    s_waitcnt lgkmcnt(3)
    v_exp_f32 v30, v30
    v_mfma_f32_16x16x32_bf16 v[32:35], a[208:211], v[204:207], v[4:7]
    s_waitcnt lgkmcnt(2)
    v_add_f32 v12, v12, v29
    v_add_f32 v12, v12, v30
    v_mfma_f32_16x16x32_bf16 v[32:35], a[212:215], v[208:211], v[32:35]
    s_waitcnt lgkmcnt(1)
    v_exp_f32 v31, v31
    v_mfma_f32_16x16x32_bf16 v[32:35], a[216:219], v[212:215], v[32:35]
    s_waitcnt lgkmcnt(0)
    v_add_f32 v12, v12, v31
    v_cvt_pk_bf16_f32 v39, v30, v31
    v_mfma_f32_16x16x32_bf16 v[32:35], a[220:223], v[216:219], v[32:35]
    v_exp_f32 v24, v24
    v_mfma_f32_16x16x32_bf16 a[128:131], a[224:227], v[36:39], 0
    ds_read_b64_tr_b16 a[224:225], v1 offset:25344
    ds_read_b64_tr_b16 a[226:227], v1 offset:25856
    v_add_f32 v12, v12, v24
    v_mfma_f32_16x16x32_bf16 a[132:135], a[228:231], v[36:39], 0
    ds_read_b64_tr_b16 a[230:231], v1 offset:25888
    v_exp_f32 v25, v25
    v_mfma_f32_16x16x32_bf16 a[136:139], a[232:235], v[36:39], 0
    ds_read_b64_tr_b16 a[228:229], v1 offset:25376
    ds_read_b64_tr_b16 a[232:233], v1 offset:25408
    ds_read_b64_tr_b16 a[234:235], v1 offset:25920
    v_mfma_f32_16x16x32_bf16 a[140:143], a[236:239], v[36:39], 0
    ds_read_b64_tr_b16 a[236:237], v1 offset:25440
    v_exp_f32 v26, v26
    v_mfma_f32_16x16x32_bf16 a[144:147], a[240:243], v[36:39], 0
    ds_read_b64_tr_b16 a[238:239], v1 offset:25952
    ds_read_b64_tr_b16 a[240:241], v1 offset:29568
    ds_read_b64_tr_b16 a[242:243], v1 offset:30080
    v_mfma_f32_16x16x32_bf16 a[148:151], a[244:247], v[36:39], 0
    ds_read_b64_tr_b16 a[246:247], v1 offset:30112
    v_exp_f32 v27, v27
    v_mfma_f32_16x16x32_bf16 a[152:155], a[248:251], v[36:39], 0
    ds_read_b64_tr_b16 a[244:245], v1 offset:29600
    ds_read_b64_tr_b16 a[248:249], v1 offset:29632
    ds_read_b64_tr_b16 a[250:251], v1 offset:30144
    v_mfma_f32_16x16x32_bf16 a[156:159], a[252:255], v[36:39], 0
    ds_read_b64_tr_b16 a[254:255], v1 offset:30176
    v_exp_f32 v32, v32
    s_nop 0
    s_waitcnt vmcnt(4)
    s_nop 0
    s_add_u32 s36, s25, 28672
    buffer_load_dwordx4 v[140:143], v19, s[8:11], s36 offen offset:0 nt
    buffer_load_dwordx4 v[144:147], v19, s[8:11], s36 offen offset:64 nt
    buffer_load_dwordx4 v[148:151], v19, s[8:11], s36 offen offset:128 nt
    buffer_load_dwordx4 v[152:155], v19, s[8:11], s36 offen offset:192 nt
    v_lshlrev_b32 v252, 16, v124
    v_and_b32 v253, s50, v124
    v_lshlrev_b32 v254, 16, v125
    v_pk_mul_f32 v[252:253], v[252:253], s[24:25] op_sel_hi:[1,0]
    v_and_b32 v255, s50, v125
    v_pk_mul_f32 v[254:255], v[254:255], s[24:25] op_sel_hi:[1,0]
    v_cvt_pk_bf16_f32 v124, v252, v253
    v_cvt_pk_bf16_f32 v125, v254, v255
    v_lshlrev_b32 v252, 16, v126
    v_and_b32 v253, s50, v126
    v_lshlrev_b32 v254, 16, v127
    v_pk_mul_f32 v[252:253], v[252:253], s[24:25] op_sel_hi:[1,0]
    v_and_b32 v255, s50, v127
    v_pk_mul_f32 v[254:255], v[254:255], s[24:25] op_sel_hi:[1,0]
    v_cvt_pk_bf16_f32 v126, v252, v253
    v_cvt_pk_bf16_f32 v127, v254, v255
    v_lshlrev_b32 v252, 16, v128
    v_and_b32 v253, s50, v128
    v_lshlrev_b32 v254, 16, v129
    v_pk_mul_f32 v[252:253], v[252:253], s[24:25] op_sel_hi:[1,0]
    v_and_b32 v255, s50, v129
    v_pk_mul_f32 v[254:255], v[254:255], s[24:25] op_sel_hi:[1,0]
    v_cvt_pk_bf16_f32 v128, v252, v253
    v_cvt_pk_bf16_f32 v129, v254, v255
    v_lshlrev_b32 v252, 16, v130
    v_and_b32 v253, s50, v130
    v_lshlrev_b32 v254, 16, v131
    v_pk_mul_f32 v[252:253], v[252:253], s[24:25] op_sel_hi:[1,0]
    v_and_b32 v255, s50, v131
    v_pk_mul_f32 v[254:255], v[254:255], s[24:25] op_sel_hi:[1,0]
    v_cvt_pk_bf16_f32 v130, v252, v253
    v_cvt_pk_bf16_f32 v131, v254, v255
    v_lshlrev_b32 v252, 16, v132
    v_and_b32 v253, s50, v132
    v_lshlrev_b32 v254, 16, v133
    v_pk_mul_f32 v[252:253], v[252:253], s[24:25] op_sel_hi:[1,0]
    v_and_b32 v255, s50, v133
    v_pk_mul_f32 v[254:255], v[254:255], s[24:25] op_sel_hi:[1,0]
    v_cvt_pk_bf16_f32 v132, v252, v253
    v_cvt_pk_bf16_f32 v133, v254, v255
    v_lshlrev_b32 v252, 16, v134
    v_and_b32 v253, s50, v134
    v_lshlrev_b32 v254, 16, v135
    v_pk_mul_f32 v[252:253], v[252:253], s[24:25] op_sel_hi:[1,0]
    v_and_b32 v255, s50, v135
    v_pk_mul_f32 v[254:255], v[254:255], s[24:25] op_sel_hi:[1,0]
    v_cvt_pk_bf16_f32 v134, v252, v253
    v_cvt_pk_bf16_f32 v135, v254, v255
    v_lshlrev_b32 v252, 16, v136
    v_and_b32 v253, s50, v136
    v_lshlrev_b32 v254, 16, v137
    v_pk_mul_f32 v[252:253], v[252:253], s[24:25] op_sel_hi:[1,0]
    v_and_b32 v255, s50, v137
    v_pk_mul_f32 v[254:255], v[254:255], s[24:25] op_sel_hi:[1,0]
    v_cvt_pk_bf16_f32 v136, v252, v253
    v_cvt_pk_bf16_f32 v137, v254, v255
    v_lshlrev_b32 v252, 16, v138
    v_and_b32 v253, s50, v138
    v_lshlrev_b32 v254, 16, v139
    v_pk_mul_f32 v[252:253], v[252:253], s[24:25] op_sel_hi:[1,0]
    v_and_b32 v255, s50, v139
    v_pk_mul_f32 v[254:255], v[254:255], s[24:25] op_sel_hi:[1,0]
    v_cvt_pk_bf16_f32 v138, v252, v253
    v_cvt_pk_bf16_f32 v139, v254, v255
    ds_write_b128 v2, v[124:127] offset:512
    ds_write_b128 v2, v[128:131] offset:576
    ds_write_b128 v2, v[132:135] offset:4736
    ds_write_b128 v2, v[136:139] offset:4800
    s_nop 1
    v_mfma_f32_16x16x32_bf16 v[20:23], a[192:195], v[124:127], v[4:7]
    ds_read_b64_tr_b16 a[252:253], v1 offset:29664
    ds_read_b128 a[192:195], v0 offset:0
    v_cvt_pk_bf16_f32 v41, v26, v27
    v_mfma_f32_16x16x32_bf16 v[20:23], a[196:199], v[128:131], v[20:23]
    ds_read_b128 a[196:199], v0 offset:64
    v_exp_f32 v33, v33
    v_mfma_f32_16x16x32_bf16 v[20:23], a[200:203], v[132:135], v[20:23]
    ds_read_b128 a[200:203], v0 offset:4224
    v_cvt_pk_bf16_f32 v40, v24, v25
    v_cvt_pk_bf16_f32 v42, v32, v33
    v_mfma_f32_16x16x32_bf16 v[20:23], a[204:207], v[136:139], v[20:23]
    ds_read_b128 a[204:207], v0 offset:4288
    v_exp_f32 v34, v34
    v_mfma_f32_16x16x32_bf16 v[28:31], a[208:211], v[124:127], v[4:7]
    ds_read_b128 a[208:211], v0 offset:512
    v_add_f32 v12, v12, v25
    v_add_f32 v12, v12, v32
    v_mfma_f32_16x16x32_bf16 v[28:31], a[212:215], v[128:131], v[28:31]
    ds_read_b128 a[212:215], v0 offset:576
    v_exp_f32 v35, v35
    v_mfma_f32_16x16x32_bf16 v[28:31], a[216:219], v[132:135], v[28:31]
    ds_read_b128 a[216:219], v0 offset:4736
    ds_read_b128 v[108:111], v2 offset:512
    v_cvt_pk_bf16_f32 v43, v34, v35
    v_mfma_f32_16x16x32_bf16 v[28:31], a[220:223], v[136:139], v[28:31]
    s_waitcnt lgkmcnt(15)
    ds_read_b128 a[220:223], v0 offset:4800
    v_exp_f32 v20, v20
    v_mfma_f32_16x16x32_bf16 a[128:131], a[224:227], v[40:43], a[128:131]
    ds_read_b128 v[112:115], v2 offset:576
    ds_read_b128 v[116:119], v2 offset:4736
    v_add_f32 v12, v12, v34
    v_mfma_f32_16x16x32_bf16 a[132:135], a[228:231], v[40:43], a[132:135]
    ds_read_b128 v[120:123], v2 offset:4800
    v_exp_f32 v21, v21
    v_mfma_f32_16x16x32_bf16 a[136:139], a[232:235], v[40:43], a[136:139]
    v_add_f32 v13, v13, v20
    v_add_f32 v13, v13, v21
    v_cvt_pk_bf16_f32 v36, v20, v21
    v_mfma_f32_16x16x32_bf16 a[140:143], a[236:239], v[40:43], a[140:143]
    v_exp_f32 v22, v22
    v_mfma_f32_16x16x32_bf16 a[144:147], a[240:243], v[40:43], a[144:147]
    v_add_f32 v12, v12, v27
    v_add_f32 v12, v12, v33
    v_add_f32 v13, v13, v22
    v_mfma_f32_16x16x32_bf16 a[148:151], a[244:247], v[40:43], a[148:151]
    s_waitcnt lgkmcnt(15)
    v_exp_f32 v23, v23
    v_mfma_f32_16x16x32_bf16 a[152:155], a[248:251], v[40:43], a[152:155]
    s_waitcnt lgkmcnt(12)
    v_add_f32 v12, v12, v26
    v_cvt_pk_bf16_f32 v37, v22, v23
    v_mfma_f32_16x16x32_bf16 a[156:159], a[252:255], v[40:43], a[156:159]
    s_waitcnt lgkmcnt(11)
    v_exp_f32 v28, v28
    v_mfma_f32_16x16x32_bf16 v[24:27], a[192:195], v[204:207], v[4:7]
    s_waitcnt lgkmcnt(10)
    v_add_f32 v12, v12, v35
    v_add_f32 v13, v13, v23
    v_mfma_f32_16x16x32_bf16 v[24:27], a[196:199], v[208:211], v[24:27]
    s_waitcnt lgkmcnt(9)
    v_exp_f32 v29, v29
    v_mfma_f32_16x16x32_bf16 v[24:27], a[200:203], v[212:215], v[24:27]
    s_waitcnt lgkmcnt(8)
    v_add_f32 v13, v13, v28
    v_cvt_pk_bf16_f32 v38, v28, v29
    v_mfma_f32_16x16x32_bf16 v[24:27], a[204:207], v[216:219], v[24:27]
    s_waitcnt lgkmcnt(7)
    v_exp_f32 v30, v30
    v_mfma_f32_16x16x32_bf16 v[32:35], a[208:211], v[204:207], v[4:7]
    s_waitcnt lgkmcnt(6)
    v_add_f32 v13, v13, v29
    v_add_f32 v13, v13, v30
    v_mfma_f32_16x16x32_bf16 v[32:35], a[212:215], v[208:211], v[32:35]
    s_waitcnt lgkmcnt(5)
    v_exp_f32 v31, v31
    v_mfma_f32_16x16x32_bf16 v[32:35], a[216:219], v[212:215], v[32:35]
    s_waitcnt lgkmcnt(3)
    v_add_f32 v13, v13, v31
    v_cvt_pk_bf16_f32 v39, v30, v31
    v_mfma_f32_16x16x32_bf16 v[32:35], a[220:223], v[216:219], v[32:35]
    v_exp_f32 v24, v24
    v_mfma_f32_16x16x32_bf16 a[160:163], a[224:227], v[36:39], 0
    ds_read_b64_tr_b16 a[224:225], v1 offset:0
    ds_read_b64_tr_b16 a[226:227], v1 offset:512
    v_add_f32 v12, v12, v24
    v_mfma_f32_16x16x32_bf16 a[164:167], a[228:231], v[36:39], 0
    ds_read_b64_tr_b16 a[230:231], v1 offset:544
    v_exp_f32 v25, v25
    v_mfma_f32_16x16x32_bf16 a[168:171], a[232:235], v[36:39], 0
    ds_read_b64_tr_b16 a[228:229], v1 offset:32
    ds_read_b64_tr_b16 a[232:233], v1 offset:64
    ds_read_b64_tr_b16 a[234:235], v1 offset:576
    v_mfma_f32_16x16x32_bf16 a[172:175], a[236:239], v[36:39], 0
    ds_read_b64_tr_b16 a[236:237], v1 offset:96
    v_exp_f32 v26, v26
    v_mfma_f32_16x16x32_bf16 a[176:179], a[240:243], v[36:39], 0
    ds_read_b64_tr_b16 a[238:239], v1 offset:608
    ds_read_b64_tr_b16 a[240:241], v1 offset:4224
    ds_read_b64_tr_b16 a[242:243], v1 offset:4736
    v_mfma_f32_16x16x32_bf16 a[180:183], a[244:247], v[36:39], 0
    ds_read_b64_tr_b16 a[244:245], v1 offset:4256
    v_exp_f32 v27, v27
    v_mfma_f32_16x16x32_bf16 a[184:187], a[248:251], v[36:39], 0
    ds_read_b64_tr_b16 a[246:247], v1 offset:4768
    ds_read_b64_tr_b16 a[248:249], v1 offset:4288
    ds_read_b64_tr_b16 a[250:251], v1 offset:4800
    v_mfma_f32_16x16x32_bf16 a[188:191], a[252:255], v[36:39], 0
    ds_read_b64_tr_b16 a[254:255], v1 offset:4832
    v_exp_f32 v32, v32
    v_mfma_f32_16x16x32_bf16 v[20:23], a[192:195], v[108:111], v[4:7]
    s_waitcnt lgkmcnt(15)
    ds_read_b64_tr_b16 a[252:253], v1 offset:4320
    v_cvt_pk_bf16_f32 v40, v24, v25
    v_cvt_pk_bf16_f32 v41, v26, v27
    v_mfma_f32_16x16x32_bf16 v[20:23], a[196:199], v[112:115], v[20:23]
    v_exp_f32 v33, v33
    v_mfma_f32_16x16x32_bf16 v[20:23], a[200:203], v[116:119], v[20:23]
    v_add_f32 v12, v12, v26
    v_add_f32 v12, v12, v32
    v_cvt_pk_bf16_f32 v42, v32, v33
    v_mfma_f32_16x16x32_bf16 v[20:23], a[204:207], v[120:123], v[20:23]
    v_exp_f32 v34, v34
    v_mfma_f32_16x16x32_bf16 v[28:31], a[208:211], v[108:111], v[4:7]
    v_add_f32 v12, v12, v25
    v_add_f32 v12, v12, v33
    v_mfma_f32_16x16x32_bf16 v[28:31], a[212:215], v[112:115], v[28:31]
    v_exp_f32 v35, v35
    v_mfma_f32_16x16x32_bf16 v[28:31], a[216:219], v[116:119], v[28:31]
    v_add_f32 v12, v12, v34
    v_cvt_pk_bf16_f32 v43, v34, v35
    v_mfma_f32_16x16x32_bf16 v[28:31], a[220:223], v[120:123], v[28:31]
    s_waitcnt lgkmcnt(14)
    v_exp_f32 v20, v20
    v_mfma_f32_16x16x32_bf16 a[128:131], a[224:227], v[40:43], a[128:131]
    s_waitcnt lgkmcnt(12)
    v_add_f32 v12, v12, v27
    v_add_f32 v12, v12, v35
    v_mfma_f32_16x16x32_bf16 a[132:135], a[228:231], v[40:43], a[132:135]
    s_waitcnt lgkmcnt(10)
    v_exp_f32 v21, v21
    v_mfma_f32_16x16x32_bf16 a[136:139], a[232:235], v[40:43], a[136:139]
    s_waitcnt lgkmcnt(8)
    v_add_f32 v13, v13, v20
    v_cvt_pk_bf16_f32 v36, v20, v21
    v_mfma_f32_16x16x32_bf16 a[140:143], a[236:239], v[40:43], a[140:143]
    s_waitcnt lgkmcnt(6)
    v_exp_f32 v22, v22
    v_mfma_f32_16x16x32_bf16 a[144:147], a[240:243], v[40:43], a[144:147]
    s_waitcnt lgkmcnt(4)
    v_add_f32 v13, v13, v21
    v_add_f32 v13, v13, v22
    v_mfma_f32_16x16x32_bf16 a[148:151], a[244:247], v[40:43], a[148:151]
    s_waitcnt lgkmcnt(2)
    v_exp_f32 v23, v23
    v_mfma_f32_16x16x32_bf16 a[152:155], a[248:251], v[40:43], a[152:155]
    s_waitcnt lgkmcnt(0)
    v_add_f32 v13, v13, v23
    v_cvt_pk_bf16_f32 v37, v22, v23
    v_mfma_f32_16x16x32_bf16 a[156:159], a[252:255], v[40:43], a[156:159]
    v_exp_f32 v28, v28
    s_nop 0
    s_waitcnt vmcnt(4)
    s_nop 0
    s_add_u32 s36, s25, 32768
    buffer_load_dwordx4 v[236:239], v19, s[8:11], s36 offen offset:0 nt
    buffer_load_dwordx4 v[240:243], v19, s[8:11], s36 offen offset:64 nt
    buffer_load_dwordx4 v[244:247], v19, s[8:11], s36 offen offset:128 nt
    buffer_load_dwordx4 v[248:251], v19, s[8:11], s36 offen offset:192 nt
    v_lshlrev_b32 v252, 16, v220
    v_and_b32 v253, s50, v220
    v_lshlrev_b32 v254, 16, v221
    v_pk_mul_f32 v[252:253], v[252:253], s[24:25] op_sel_hi:[1,0]
    v_and_b32 v255, s50, v221
    v_pk_mul_f32 v[254:255], v[254:255], s[24:25] op_sel_hi:[1,0]
    v_cvt_pk_bf16_f32 v220, v252, v253
    v_cvt_pk_bf16_f32 v221, v254, v255
    v_lshlrev_b32 v252, 16, v222
    v_and_b32 v253, s50, v222
    v_lshlrev_b32 v254, 16, v223
    v_pk_mul_f32 v[252:253], v[252:253], s[24:25] op_sel_hi:[1,0]
    v_and_b32 v255, s50, v223
    v_pk_mul_f32 v[254:255], v[254:255], s[24:25] op_sel_hi:[1,0]
    v_cvt_pk_bf16_f32 v222, v252, v253
    v_cvt_pk_bf16_f32 v223, v254, v255
    v_lshlrev_b32 v252, 16, v224
    v_and_b32 v253, s50, v224
    v_lshlrev_b32 v254, 16, v225
    v_pk_mul_f32 v[252:253], v[252:253], s[24:25] op_sel_hi:[1,0]
    v_and_b32 v255, s50, v225
    v_pk_mul_f32 v[254:255], v[254:255], s[24:25] op_sel_hi:[1,0]
    v_cvt_pk_bf16_f32 v224, v252, v253
    v_cvt_pk_bf16_f32 v225, v254, v255
    v_lshlrev_b32 v252, 16, v226
    v_and_b32 v253, s50, v226
    v_lshlrev_b32 v254, 16, v227
    v_pk_mul_f32 v[252:253], v[252:253], s[24:25] op_sel_hi:[1,0]
    v_and_b32 v255, s50, v227
    v_pk_mul_f32 v[254:255], v[254:255], s[24:25] op_sel_hi:[1,0]
    v_cvt_pk_bf16_f32 v226, v252, v253
    v_cvt_pk_bf16_f32 v227, v254, v255
    v_lshlrev_b32 v252, 16, v228
    v_and_b32 v253, s50, v228
    v_lshlrev_b32 v254, 16, v229
    v_pk_mul_f32 v[252:253], v[252:253], s[24:25] op_sel_hi:[1,0]
    v_and_b32 v255, s50, v229
    v_pk_mul_f32 v[254:255], v[254:255], s[24:25] op_sel_hi:[1,0]
    v_cvt_pk_bf16_f32 v228, v252, v253
    v_cvt_pk_bf16_f32 v229, v254, v255
    v_lshlrev_b32 v252, 16, v230
    v_and_b32 v253, s50, v230
    v_lshlrev_b32 v254, 16, v231
    v_pk_mul_f32 v[252:253], v[252:253], s[24:25] op_sel_hi:[1,0]
    v_and_b32 v255, s50, v231
    v_pk_mul_f32 v[254:255], v[254:255], s[24:25] op_sel_hi:[1,0]
    v_cvt_pk_bf16_f32 v230, v252, v253
    v_cvt_pk_bf16_f32 v231, v254, v255
    v_lshlrev_b32 v252, 16, v232
    v_and_b32 v253, s50, v232
    v_lshlrev_b32 v254, 16, v233
    v_pk_mul_f32 v[252:253], v[252:253], s[24:25] op_sel_hi:[1,0]
    v_and_b32 v255, s50, v233
    v_pk_mul_f32 v[254:255], v[254:255], s[24:25] op_sel_hi:[1,0]
    v_cvt_pk_bf16_f32 v232, v252, v253
    v_cvt_pk_bf16_f32 v233, v254, v255
    v_lshlrev_b32 v252, 16, v234
    v_and_b32 v253, s50, v234
    v_lshlrev_b32 v254, 16, v235
    v_pk_mul_f32 v[252:253], v[252:253], s[24:25] op_sel_hi:[1,0]
    v_and_b32 v255, s50, v235
    v_pk_mul_f32 v[254:255], v[254:255], s[24:25] op_sel_hi:[1,0]
    v_cvt_pk_bf16_f32 v234, v252, v253
    v_cvt_pk_bf16_f32 v235, v254, v255
    s_nop 1
    v_mfma_f32_16x16x32_bf16 v[24:27], a[192:195], v[220:223], v[4:7]
    ds_read_b128 a[192:195], v0 offset:8448
    v_add_f32 v13, v13, v28
    v_mfma_f32_16x16x32_bf16 v[24:27], a[196:199], v[224:227], v[24:27]
    ds_read_b128 a[196:199], v0 offset:8512
    v_exp_f32 v29, v29
    v_mfma_f32_16x16x32_bf16 v[24:27], a[200:203], v[228:231], v[24:27]
    ds_read_b128 a[200:203], v0 offset:12672
    v_cvt_pk_bf16_f32 v38, v28, v29
    v_mfma_f32_16x16x32_bf16 v[24:27], a[204:207], v[232:235], v[24:27]
    v_exp_f32 v30, v30
    v_mfma_f32_16x16x32_bf16 v[32:35], a[208:211], v[220:223], v[4:7]
    ds_read_b128 a[204:207], v0 offset:12736
    ds_read_b128 a[208:211], v0 offset:8960
    v_mfma_f32_16x16x32_bf16 v[32:35], a[212:215], v[224:227], v[32:35]
    ds_read_b128 a[212:215], v0 offset:9024
    v_exp_f32 v31, v31
    v_mfma_f32_16x16x32_bf16 v[32:35], a[216:219], v[228:231], v[32:35]
    ds_read_b128 a[216:219], v0 offset:13184
    v_cvt_pk_bf16_f32 v39, v30, v31
    v_mfma_f32_16x16x32_bf16 v[32:35], a[220:223], v[232:235], v[32:35]
    v_exp_f32 v24, v24
    v_mfma_f32_16x16x32_bf16 a[160:163], a[224:227], v[36:39], a[160:163]
    ds_read_b128 a[220:223], v0 offset:13248
    v_add_f32 v13, v13, v30
    v_mfma_f32_16x16x32_bf16 a[164:167], a[228:231], v[36:39], a[164:167]
    v_exp_f32 v25, v25
    v_mfma_f32_16x16x32_bf16 a[168:171], a[232:235], v[36:39], a[168:171]
    v_add_f32 v14, v14, v24
    v_cvt_pk_bf16_f32 v40, v24, v25
    v_mfma_f32_16x16x32_bf16 a[172:175], a[236:239], v[36:39], a[172:175]
    v_exp_f32 v26, v26
    v_mfma_f32_16x16x32_bf16 a[176:179], a[240:243], v[36:39], a[176:179]
    v_add_f32 v13, v13, v29
    v_add_f32 v14, v14, v25
    v_mfma_f32_16x16x32_bf16 a[180:183], a[244:247], v[36:39], a[180:183]
    v_exp_f32 v27, v27
    v_mfma_f32_16x16x32_bf16 a[184:187], a[248:251], v[36:39], a[184:187]
    v_add_f32 v14, v14, v26
    v_cvt_pk_bf16_f32 v41, v26, v27
    v_mfma_f32_16x16x32_bf16 a[188:191], a[252:255], v[36:39], a[188:191]
    s_waitcnt lgkmcnt(7)
    v_exp_f32 v32, v32
    v_mfma_f32_16x16x32_bf16 v[20:23], a[192:195], v[108:111], v[4:7]
    s_waitcnt lgkmcnt(6)
    v_add_f32 v13, v13, v31
    v_add_f32 v14, v14, v27
    v_mfma_f32_16x16x32_bf16 v[20:23], a[196:199], v[112:115], v[20:23]
    s_waitcnt lgkmcnt(5)
    v_exp_f32 v33, v33
    v_mfma_f32_16x16x32_bf16 v[20:23], a[200:203], v[116:119], v[20:23]
    s_waitcnt lgkmcnt(4)
    v_add_f32 v14, v14, v32
    v_cvt_pk_bf16_f32 v42, v32, v33
    v_mfma_f32_16x16x32_bf16 v[20:23], a[204:207], v[120:123], v[20:23]
    s_waitcnt lgkmcnt(3)
    v_exp_f32 v34, v34
    v_mfma_f32_16x16x32_bf16 v[28:31], a[208:211], v[108:111], v[4:7]
    s_waitcnt lgkmcnt(2)
    v_add_f32 v14, v14, v33
    v_add_f32 v14, v14, v34
    v_mfma_f32_16x16x32_bf16 v[28:31], a[212:215], v[112:115], v[28:31]
    s_waitcnt lgkmcnt(1)
    v_exp_f32 v35, v35
    v_mfma_f32_16x16x32_bf16 v[28:31], a[216:219], v[116:119], v[28:31]
    s_waitcnt lgkmcnt(0)
    v_add_f32 v14, v14, v35
    v_cvt_pk_bf16_f32 v43, v34, v35
    v_mfma_f32_16x16x32_bf16 v[28:31], a[220:223], v[120:123], v[28:31]
    v_exp_f32 v20, v20
    v_mfma_f32_16x16x32_bf16 v[44:47], a[224:227], v[40:43], 0
    ds_read_b64_tr_b16 a[224:225], v1 offset:8448
    ds_read_b64_tr_b16 a[226:227], v1 offset:8960
    v_add_f32 v13, v13, v20
    v_mfma_f32_16x16x32_bf16 v[48:51], a[228:231], v[40:43], 0
    ds_read_b64_tr_b16 a[228:229], v1 offset:8480
    v_exp_f32 v21, v21
    v_mfma_f32_16x16x32_bf16 v[52:55], a[232:235], v[40:43], 0
    ds_read_b64_tr_b16 a[230:231], v1 offset:8992
    ds_read_b64_tr_b16 a[232:233], v1 offset:8512
    ds_read_b64_tr_b16 a[234:235], v1 offset:9024
    v_mfma_f32_16x16x32_bf16 v[56:59], a[236:239], v[40:43], 0
    ds_read_b64_tr_b16 a[238:239], v1 offset:9056
    v_exp_f32 v22, v22
    v_mfma_f32_16x16x32_bf16 v[60:63], a[240:243], v[40:43], 0
    ds_read_b64_tr_b16 a[236:237], v1 offset:8544
    ds_read_b64_tr_b16 a[240:241], v1 offset:12672
    ds_read_b64_tr_b16 a[242:243], v1 offset:13184
    v_mfma_f32_16x16x32_bf16 v[64:67], a[244:247], v[40:43], 0
    ds_read_b64_tr_b16 a[246:247], v1 offset:13216
    v_exp_f32 v23, v23
    v_mfma_f32_16x16x32_bf16 v[68:71], a[248:251], v[40:43], 0
    ds_read_b64_tr_b16 a[244:245], v1 offset:12704
    ds_read_b64_tr_b16 a[248:249], v1 offset:12736
    ds_read_b64_tr_b16 a[250:251], v1 offset:13248
    v_mfma_f32_16x16x32_bf16 v[72:75], a[252:255], v[40:43], 0
    ds_read_b64_tr_b16 a[252:253], v1 offset:12768
    v_exp_f32 v28, v28
    v_mfma_f32_16x16x32_bf16 v[24:27], a[192:195], v[220:223], v[4:7]
    ds_read_b64_tr_b16 a[254:255], v1 offset:13280
    ds_read_b128 a[192:195], v0 offset:25344
    v_cvt_pk_bf16_f32 v37, v22, v23
    v_mfma_f32_16x16x32_bf16 v[24:27], a[196:199], v[224:227], v[24:27]
    ds_read_b128 a[196:199], v0 offset:25408
    v_exp_f32 v29, v29
    v_mfma_f32_16x16x32_bf16 v[24:27], a[200:203], v[228:231], v[24:27]
    ds_read_b128 a[200:203], v0 offset:29568
    v_cvt_pk_bf16_f32 v36, v20, v21
    v_cvt_pk_bf16_f32 v38, v28, v29
    v_mfma_f32_16x16x32_bf16 v[24:27], a[204:207], v[232:235], v[24:27]
    ds_read_b128 a[204:207], v0 offset:29632
    v_exp_f32 v30, v30
    v_mfma_f32_16x16x32_bf16 v[32:35], a[208:211], v[220:223], v[4:7]
    ds_read_b128 a[208:211], v0 offset:25856
    v_add_f32 v13, v13, v28
    v_add_f32 v13, v13, v29
    v_mfma_f32_16x16x32_bf16 v[32:35], a[212:215], v[224:227], v[32:35]
    ds_read_b128 a[212:215], v0 offset:25920
    v_exp_f32 v31, v31
    v_mfma_f32_16x16x32_bf16 v[32:35], a[216:219], v[228:231], v[32:35]
    ds_read_b128 a[216:219], v0 offset:30080
    v_add_f32 v13, v13, v30
    v_cvt_pk_bf16_f32 v39, v30, v31
    v_mfma_f32_16x16x32_bf16 v[32:35], a[220:223], v[232:235], v[32:35]
    s_waitcnt lgkmcnt(15)
    ds_read_b128 a[220:223], v0 offset:30144
    v_exp_f32 v24, v24
    v_mfma_f32_16x16x32_bf16 a[160:163], a[224:227], v[36:39], a[160:163]
    v_add_f32 v13, v13, v21
    v_add_f32 v13, v13, v31
    v_mfma_f32_16x16x32_bf16 a[164:167], a[228:231], v[36:39], a[164:167]
    v_exp_f32 v25, v25
    v_mfma_f32_16x16x32_bf16 a[168:171], a[232:235], v[36:39], a[168:171]
    v_add_f32 v14, v14, v24
    v_cvt_pk_bf16_f32 v40, v24, v25
    v_mfma_f32_16x16x32_bf16 a[172:175], a[236:239], v[36:39], a[172:175]
    s_waitcnt lgkmcnt(14)
    v_exp_f32 v26, v26
    v_mfma_f32_16x16x32_bf16 a[176:179], a[240:243], v[36:39], a[176:179]
    s_waitcnt lgkmcnt(12)
    v_add_f32 v13, v13, v23
    v_add_f32 v14, v14, v26
    v_mfma_f32_16x16x32_bf16 a[180:183], a[244:247], v[36:39], a[180:183]
    s_waitcnt lgkmcnt(10)
    v_exp_f32 v27, v27
    v_mfma_f32_16x16x32_bf16 a[184:187], a[248:251], v[36:39], a[184:187]
    s_waitcnt lgkmcnt(8)
    v_add_f32 v13, v13, v22
    v_cvt_pk_bf16_f32 v41, v26, v27
    v_mfma_f32_16x16x32_bf16 a[188:191], a[252:255], v[36:39], a[188:191]
    s_waitcnt lgkmcnt(7)
    v_exp_f32 v32, v32
    v_mfma_f32_16x16x32_bf16 v[20:23], a[192:195], v[220:223], v[4:7]
    s_waitcnt lgkmcnt(6)
    v_add_f32 v14, v14, v25
    v_add_f32 v14, v14, v27
    v_mfma_f32_16x16x32_bf16 v[20:23], a[196:199], v[224:227], v[20:23]
    s_waitcnt lgkmcnt(5)
    v_exp_f32 v33, v33
    v_mfma_f32_16x16x32_bf16 v[20:23], a[200:203], v[228:231], v[20:23]
    s_waitcnt lgkmcnt(4)
    v_add_f32 v14, v14, v32
    v_cvt_pk_bf16_f32 v42, v32, v33
    v_mfma_f32_16x16x32_bf16 v[20:23], a[204:207], v[232:235], v[20:23]
    s_waitcnt lgkmcnt(3)
    v_exp_f32 v34, v34
    v_mfma_f32_16x16x32_bf16 v[28:31], a[208:211], v[220:223], v[4:7]
    s_waitcnt lgkmcnt(2)
    v_add_f32 v14, v14, v33
    v_add_f32 v14, v14, v34
    v_mfma_f32_16x16x32_bf16 v[28:31], a[212:215], v[224:227], v[28:31]
    s_waitcnt lgkmcnt(1)
    v_exp_f32 v35, v35
    v_mfma_f32_16x16x32_bf16 v[28:31], a[216:219], v[228:231], v[28:31]
    s_waitcnt lgkmcnt(0)
    v_add_f32 v14, v14, v35
    v_cvt_pk_bf16_f32 v43, v34, v35
    v_mfma_f32_16x16x32_bf16 v[28:31], a[220:223], v[232:235], v[28:31]
    v_exp_f32 v20, v20
    v_mfma_f32_16x16x32_bf16 v[44:47], a[224:227], v[40:43], v[44:47]
    ds_read_b64_tr_b16 a[224:225], v1 offset:25344
    ds_read_b64_tr_b16 a[226:227], v1 offset:25856
    v_add_f32 v14, v14, v20
    v_mfma_f32_16x16x32_bf16 v[48:51], a[228:231], v[40:43], v[48:51]
    ds_read_b64_tr_b16 a[228:229], v1 offset:25376
    v_exp_f32 v21, v21
    v_mfma_f32_16x16x32_bf16 v[52:55], a[232:235], v[40:43], v[52:55]
    ds_read_b64_tr_b16 a[230:231], v1 offset:25888
    ds_read_b64_tr_b16 a[232:233], v1 offset:25408
    ds_read_b64_tr_b16 a[234:235], v1 offset:25920
    v_mfma_f32_16x16x32_bf16 v[56:59], a[236:239], v[40:43], v[56:59]
    ds_read_b64_tr_b16 a[238:239], v1 offset:25952
    v_exp_f32 v22, v22
    v_mfma_f32_16x16x32_bf16 v[60:63], a[240:243], v[40:43], v[60:63]
    ds_read_b64_tr_b16 a[236:237], v1 offset:25440
    ds_read_b64_tr_b16 a[240:241], v1 offset:29568
    ds_read_b64_tr_b16 a[242:243], v1 offset:30080
    v_mfma_f32_16x16x32_bf16 v[64:67], a[244:247], v[40:43], v[64:67]
    ds_read_b64_tr_b16 a[246:247], v1 offset:30112
    v_exp_f32 v23, v23
    v_mfma_f32_16x16x32_bf16 v[68:71], a[248:251], v[40:43], v[68:71]
    ds_read_b64_tr_b16 a[244:245], v1 offset:29600
    ds_read_b64_tr_b16 a[248:249], v1 offset:29632
    ds_read_b64_tr_b16 a[250:251], v1 offset:30144
    v_mfma_f32_16x16x32_bf16 v[72:75], a[252:255], v[40:43], v[72:75]
    ds_read_b64_tr_b16 a[252:253], v1 offset:29664
    v_exp_f32 v28, v28
    s_nop 0
    s_waitcnt vmcnt(4)
    s_nop 0
    s_lshl_b32 s37, s4, 9
    s_add_u32 s37, s37, 24576
    s_add_u32 m0, s35, 16896
    s_nop 0
    buffer_load_dwordx4 v3, s[12:15], s37 offen nt lds
    s_add_u32 m0, s35, 20992
    s_nop 0
    buffer_load_dwordx4 v3, s[12:15], s37 offen offset:128 nt lds
    s_add_u32 m0, s35, 50688
    s_nop 0
    buffer_load_dwordx4 v3, s[16:19], s37 offen nt lds
    s_add_u32 m0, s35, 54784
    s_nop 0
    buffer_load_dwordx4 v3, s[16:19], s37 offen offset:128 nt lds
    v_lshlrev_b32 v252, 16, v140
    v_and_b32 v253, s50, v140
    v_lshlrev_b32 v254, 16, v141
    v_pk_mul_f32 v[252:253], v[252:253], s[24:25] op_sel_hi:[1,0]
    v_and_b32 v255, s50, v141
    v_pk_mul_f32 v[254:255], v[254:255], s[24:25] op_sel_hi:[1,0]
    v_cvt_pk_bf16_f32 v140, v252, v253
    v_cvt_pk_bf16_f32 v141, v254, v255
    v_lshlrev_b32 v252, 16, v142
    v_and_b32 v253, s50, v142
    v_lshlrev_b32 v254, 16, v143
    v_pk_mul_f32 v[252:253], v[252:253], s[24:25] op_sel_hi:[1,0]
    v_and_b32 v255, s50, v143
    v_pk_mul_f32 v[254:255], v[254:255], s[24:25] op_sel_hi:[1,0]
    v_cvt_pk_bf16_f32 v142, v252, v253
    v_cvt_pk_bf16_f32 v143, v254, v255
    v_lshlrev_b32 v252, 16, v144
    v_and_b32 v253, s50, v144
    v_lshlrev_b32 v254, 16, v145
    v_pk_mul_f32 v[252:253], v[252:253], s[24:25] op_sel_hi:[1,0]
    v_and_b32 v255, s50, v145
    v_pk_mul_f32 v[254:255], v[254:255], s[24:25] op_sel_hi:[1,0]
    v_cvt_pk_bf16_f32 v144, v252, v253
    v_cvt_pk_bf16_f32 v145, v254, v255
    v_lshlrev_b32 v252, 16, v146
    v_and_b32 v253, s50, v146
    v_lshlrev_b32 v254, 16, v147
    v_pk_mul_f32 v[252:253], v[252:253], s[24:25] op_sel_hi:[1,0]
    v_and_b32 v255, s50, v147
    v_pk_mul_f32 v[254:255], v[254:255], s[24:25] op_sel_hi:[1,0]
    v_cvt_pk_bf16_f32 v146, v252, v253
    v_cvt_pk_bf16_f32 v147, v254, v255
    v_lshlrev_b32 v252, 16, v148
    v_and_b32 v253, s50, v148
    v_lshlrev_b32 v254, 16, v149
    v_pk_mul_f32 v[252:253], v[252:253], s[24:25] op_sel_hi:[1,0]
    v_and_b32 v255, s50, v149
    v_pk_mul_f32 v[254:255], v[254:255], s[24:25] op_sel_hi:[1,0]
    v_cvt_pk_bf16_f32 v148, v252, v253
    v_cvt_pk_bf16_f32 v149, v254, v255
    v_lshlrev_b32 v252, 16, v150
    v_and_b32 v253, s50, v150
    v_lshlrev_b32 v254, 16, v151
    v_pk_mul_f32 v[252:253], v[252:253], s[24:25] op_sel_hi:[1,0]
    v_and_b32 v255, s50, v151
    v_pk_mul_f32 v[254:255], v[254:255], s[24:25] op_sel_hi:[1,0]
    v_cvt_pk_bf16_f32 v150, v252, v253
    v_cvt_pk_bf16_f32 v151, v254, v255
    v_lshlrev_b32 v252, 16, v152
    v_and_b32 v253, s50, v152
    v_lshlrev_b32 v254, 16, v153
    v_pk_mul_f32 v[252:253], v[252:253], s[24:25] op_sel_hi:[1,0]
    v_and_b32 v255, s50, v153
    v_pk_mul_f32 v[254:255], v[254:255], s[24:25] op_sel_hi:[1,0]
    v_cvt_pk_bf16_f32 v152, v252, v253
    v_cvt_pk_bf16_f32 v153, v254, v255
    v_lshlrev_b32 v252, 16, v154
    v_and_b32 v253, s50, v154
    v_lshlrev_b32 v254, 16, v155
    v_pk_mul_f32 v[252:253], v[252:253], s[24:25] op_sel_hi:[1,0]
    v_and_b32 v255, s50, v155
    v_pk_mul_f32 v[254:255], v[254:255], s[24:25] op_sel_hi:[1,0]
    v_cvt_pk_bf16_f32 v154, v252, v253
    v_cvt_pk_bf16_f32 v155, v254, v255
    ds_write_b128 v2, v[140:143] offset:8448
    ds_write_b128 v2, v[144:147] offset:8512
    ds_write_b128 v2, v[148:151] offset:12672
    ds_write_b128 v2, v[152:155] offset:12736
    s_nop 1
    v_mfma_f32_16x16x32_bf16 v[24:27], a[192:195], v[140:143], v[4:7]
    ds_read_b64_tr_b16 a[254:255], v1 offset:30176
    v_cvt_pk_bf16_f32 v36, v20, v21
    v_cvt_pk_bf16_f32 v37, v22, v23
    v_mfma_f32_16x16x32_bf16 v[24:27], a[196:199], v[144:147], v[24:27]
    v_exp_f32 v29, v29
    v_mfma_f32_16x16x32_bf16 v[24:27], a[200:203], v[148:151], v[24:27]
    v_add_f32 v14, v14, v22
    v_add_f32 v14, v14, v23
    v_cvt_pk_bf16_f32 v38, v28, v29
    v_mfma_f32_16x16x32_bf16 v[24:27], a[204:207], v[152:155], v[24:27]
    v_exp_f32 v30, v30
    v_mfma_f32_16x16x32_bf16 v[32:35], a[208:211], v[140:143], v[4:7]
    v_add_f32 v14, v14, v21
    v_add_f32 v14, v14, v28
    v_add_f32 v14, v14, v29
    v_mfma_f32_16x16x32_bf16 v[32:35], a[212:215], v[144:147], v[32:35]
    v_exp_f32 v31, v31
    v_mfma_f32_16x16x32_bf16 v[32:35], a[216:219], v[148:151], v[32:35]
    ds_read_b128 v[108:111], v2 offset:8448
    v_add_f32 v14, v14, v30
    v_cvt_pk_bf16_f32 v39, v30, v31
    v_mfma_f32_16x16x32_bf16 v[32:35], a[220:223], v[152:155], v[32:35]
    s_waitcnt lgkmcnt(15)
    ds_read_b128 v[112:115], v2 offset:8512
    v_exp_f32 v24, v24
    v_mfma_f32_16x16x32_bf16 v[44:47], a[224:227], v[36:39], v[44:47]
    ds_read_b128 v[116:119], v2 offset:12672
    v_add_f32 v14, v14, v31
    v_mfma_f32_16x16x32_bf16 v[48:51], a[228:231], v[36:39], v[48:51]
    ds_read_b128 v[120:123], v2 offset:12736
    v_exp_f32 v25, v25
    v_mfma_f32_16x16x32_bf16 v[52:55], a[232:235], v[36:39], v[52:55]
    s_waitcnt lgkmcnt(15)
    v_add_f32 v15, v15, v24
    v_cvt_pk_bf16_f32 v40, v24, v25
    v_mfma_f32_16x16x32_bf16 v[56:59], a[236:239], v[36:39], v[56:59]
    s_waitcnt lgkmcnt(14)
    v_exp_f32 v26, v26
    v_mfma_f32_16x16x32_bf16 v[60:63], a[240:243], v[36:39], v[60:63]
    s_waitcnt lgkmcnt(12)
    v_add_f32 v15, v15, v25
    v_add_f32 v15, v15, v26
    v_mfma_f32_16x16x32_bf16 v[64:67], a[244:247], v[36:39], v[64:67]
    s_waitcnt lgkmcnt(10)
    v_exp_f32 v27, v27
    v_mfma_f32_16x16x32_bf16 v[68:71], a[248:251], v[36:39], v[68:71]
    s_waitcnt lgkmcnt(4)
    v_add_f32 v15, v15, v27
    v_cvt_pk_bf16_f32 v41, v26, v27
    v_mfma_f32_16x16x32_bf16 v[72:75], a[252:255], v[36:39], v[72:75]
    v_exp_f32 v32, v32
    s_nop 0
    s_waitcnt vmcnt(4)
    s_nop 0
    v_lshlrev_b32 v252, 16, v236
    v_and_b32 v253, s50, v236
    v_lshlrev_b32 v254, 16, v237
    v_pk_mul_f32 v[252:253], v[252:253], s[24:25] op_sel_hi:[1,0]
    v_and_b32 v255, s50, v237
    v_pk_mul_f32 v[254:255], v[254:255], s[24:25] op_sel_hi:[1,0]
    v_cvt_pk_bf16_f32 v236, v252, v253
    v_cvt_pk_bf16_f32 v237, v254, v255
    v_lshlrev_b32 v252, 16, v238
    v_and_b32 v253, s50, v238
    v_lshlrev_b32 v254, 16, v239
    v_pk_mul_f32 v[252:253], v[252:253], s[24:25] op_sel_hi:[1,0]
    v_and_b32 v255, s50, v239
    v_pk_mul_f32 v[254:255], v[254:255], s[24:25] op_sel_hi:[1,0]
    v_cvt_pk_bf16_f32 v238, v252, v253
    v_cvt_pk_bf16_f32 v239, v254, v255
    v_lshlrev_b32 v252, 16, v240
    v_and_b32 v253, s50, v240
    v_lshlrev_b32 v254, 16, v241
    v_pk_mul_f32 v[252:253], v[252:253], s[24:25] op_sel_hi:[1,0]
    v_and_b32 v255, s50, v241
    v_pk_mul_f32 v[254:255], v[254:255], s[24:25] op_sel_hi:[1,0]
    v_cvt_pk_bf16_f32 v240, v252, v253
    v_cvt_pk_bf16_f32 v241, v254, v255
    v_lshlrev_b32 v252, 16, v242
    v_and_b32 v253, s50, v242
    v_lshlrev_b32 v254, 16, v243
    v_pk_mul_f32 v[252:253], v[252:253], s[24:25] op_sel_hi:[1,0]
    v_and_b32 v255, s50, v243
    v_pk_mul_f32 v[254:255], v[254:255], s[24:25] op_sel_hi:[1,0]
    v_cvt_pk_bf16_f32 v242, v252, v253
    v_cvt_pk_bf16_f32 v243, v254, v255
    v_lshlrev_b32 v252, 16, v244
    v_and_b32 v253, s50, v244
    v_lshlrev_b32 v254, 16, v245
    v_pk_mul_f32 v[252:253], v[252:253], s[24:25] op_sel_hi:[1,0]
    v_and_b32 v255, s50, v245
    v_pk_mul_f32 v[254:255], v[254:255], s[24:25] op_sel_hi:[1,0]
    v_cvt_pk_bf16_f32 v244, v252, v253
    v_cvt_pk_bf16_f32 v245, v254, v255
    v_lshlrev_b32 v252, 16, v246
    v_and_b32 v253, s50, v246
    v_lshlrev_b32 v254, 16, v247
    v_pk_mul_f32 v[252:253], v[252:253], s[24:25] op_sel_hi:[1,0]
    v_and_b32 v255, s50, v247
    v_pk_mul_f32 v[254:255], v[254:255], s[24:25] op_sel_hi:[1,0]
    v_cvt_pk_bf16_f32 v246, v252, v253
    v_cvt_pk_bf16_f32 v247, v254, v255
    v_lshlrev_b32 v252, 16, v248
    v_and_b32 v253, s50, v248
    v_lshlrev_b32 v254, 16, v249
    v_pk_mul_f32 v[252:253], v[252:253], s[24:25] op_sel_hi:[1,0]
    v_and_b32 v255, s50, v249
    v_pk_mul_f32 v[254:255], v[254:255], s[24:25] op_sel_hi:[1,0]
    v_cvt_pk_bf16_f32 v248, v252, v253
    v_cvt_pk_bf16_f32 v249, v254, v255
    v_lshlrev_b32 v252, 16, v250
    v_and_b32 v253, s50, v250
    v_lshlrev_b32 v254, 16, v251
    v_pk_mul_f32 v[252:253], v[252:253], s[24:25] op_sel_hi:[1,0]
    v_and_b32 v255, s50, v251
    v_pk_mul_f32 v[254:255], v[254:255], s[24:25] op_sel_hi:[1,0]
    v_cvt_pk_bf16_f32 v250, v252, v253
    v_cvt_pk_bf16_f32 v251, v254, v255
    s_nop 1
    v_mfma_f32_16x16x32_bf16 v[20:23], a[192:195], v[236:239], v[4:7]
    ds_read_b128 a[192:195], v0 offset:0
    v_add_f32 v15, v15, v32
    v_mfma_f32_16x16x32_bf16 v[20:23], a[196:199], v[240:243], v[20:23]
    ds_read_b128 a[196:199], v0 offset:64
    v_exp_f32 v33, v33
    v_mfma_f32_16x16x32_bf16 v[20:23], a[200:203], v[244:247], v[20:23]
    ds_read_b128 a[200:203], v0 offset:4224
    v_cvt_pk_bf16_f32 v42, v32, v33
    v_mfma_f32_16x16x32_bf16 v[20:23], a[204:207], v[248:251], v[20:23]
    v_exp_f32 v34, v34
    v_mfma_f32_16x16x32_bf16 v[28:31], a[208:211], v[236:239], v[4:7]
    ds_read_b128 a[204:207], v0 offset:4288
    ds_read_b128 a[208:211], v0 offset:512
    v_mfma_f32_16x16x32_bf16 v[28:31], a[212:215], v[240:243], v[28:31]
    ds_read_b128 a[212:215], v0 offset:576
    v_exp_f32 v35, v35
    v_mfma_f32_16x16x32_bf16 v[28:31], a[216:219], v[244:247], v[28:31]
    ds_read_b128 a[216:219], v0 offset:4736
    v_cvt_pk_bf16_f32 v43, v34, v35
    v_mfma_f32_16x16x32_bf16 v[28:31], a[220:223], v[248:251], v[28:31]
    v_exp_f32 v20, v20
    v_mfma_f32_16x16x32_bf16 v[76:79], a[224:227], v[40:43], 0
    ds_read_b128 a[220:223], v0 offset:4800
    v_add_f32 v15, v15, v33
    v_mfma_f32_16x16x32_bf16 v[80:83], a[228:231], v[40:43], 0
    v_exp_f32 v21, v21
    v_mfma_f32_16x16x32_bf16 v[84:87], a[232:235], v[40:43], 0
    v_add_f32 v16, v16, v20
    v_cvt_pk_bf16_f32 v36, v20, v21
    v_mfma_f32_16x16x32_bf16 v[88:91], a[236:239], v[40:43], 0
    v_exp_f32 v22, v22
    v_mfma_f32_16x16x32_bf16 v[92:95], a[240:243], v[40:43], 0
    v_add_f32 v16, v16, v21
    v_add_f32 v16, v16, v22
    v_mfma_f32_16x16x32_bf16 v[96:99], a[244:247], v[40:43], 0
    v_exp_f32 v23, v23
    v_mfma_f32_16x16x32_bf16 v[100:103], a[248:251], v[40:43], 0
    v_add_f32 v15, v15, v34
    v_cvt_pk_bf16_f32 v37, v22, v23
    v_mfma_f32_16x16x32_bf16 v[104:107], a[252:255], v[40:43], 0
    s_waitcnt lgkmcnt(7)
    v_exp_f32 v28, v28
    v_mfma_f32_16x16x32_bf16 v[24:27], a[192:195], v[108:111], v[4:7]
    s_waitcnt lgkmcnt(6)
    v_add_f32 v15, v15, v35
    v_add_f32 v16, v16, v23
    v_mfma_f32_16x16x32_bf16 v[24:27], a[196:199], v[112:115], v[24:27]
    s_waitcnt lgkmcnt(5)
    v_exp_f32 v29, v29
    v_mfma_f32_16x16x32_bf16 v[24:27], a[200:203], v[116:119], v[24:27]
    s_waitcnt lgkmcnt(4)
    v_add_f32 v16, v16, v28
    v_cvt_pk_bf16_f32 v38, v28, v29
    v_mfma_f32_16x16x32_bf16 v[24:27], a[204:207], v[120:123], v[24:27]
    s_waitcnt lgkmcnt(3)
    v_exp_f32 v30, v30
    v_mfma_f32_16x16x32_bf16 v[32:35], a[208:211], v[108:111], v[4:7]
    s_waitcnt lgkmcnt(2)
    v_add_f32 v16, v16, v29
    v_add_f32 v16, v16, v30
    v_mfma_f32_16x16x32_bf16 v[32:35], a[212:215], v[112:115], v[32:35]
    s_waitcnt lgkmcnt(1)
    v_exp_f32 v31, v31
    v_mfma_f32_16x16x32_bf16 v[32:35], a[216:219], v[116:119], v[32:35]
    s_waitcnt lgkmcnt(0)
    v_add_f32 v16, v16, v31
    v_cvt_pk_bf16_f32 v39, v30, v31
    v_mfma_f32_16x16x32_bf16 v[32:35], a[220:223], v[120:123], v[32:35]
    v_exp_f32 v24, v24
    v_mfma_f32_16x16x32_bf16 v[124:127], a[224:227], v[36:39], 0
    ds_read_b64_tr_b16 a[224:225], v1 offset:0
    ds_read_b64_tr_b16 a[226:227], v1 offset:512
    v_add_f32 v15, v15, v24
    v_mfma_f32_16x16x32_bf16 v[128:131], a[228:231], v[36:39], 0
    ds_read_b64_tr_b16 a[230:231], v1 offset:544
    v_exp_f32 v25, v25
    v_mfma_f32_16x16x32_bf16 v[132:135], a[232:235], v[36:39], 0
    ds_read_b64_tr_b16 a[228:229], v1 offset:32
    ds_read_b64_tr_b16 a[232:233], v1 offset:64
    ds_read_b64_tr_b16 a[234:235], v1 offset:576
    v_mfma_f32_16x16x32_bf16 v[136:139], a[236:239], v[36:39], 0
    ds_read_b64_tr_b16 a[236:237], v1 offset:96
    v_exp_f32 v26, v26
    v_mfma_f32_16x16x32_bf16 v[140:143], a[240:243], v[36:39], 0
    ds_read_b64_tr_b16 a[238:239], v1 offset:608
    ds_read_b64_tr_b16 a[240:241], v1 offset:4224
    ds_read_b64_tr_b16 a[242:243], v1 offset:4736
    v_mfma_f32_16x16x32_bf16 v[144:147], a[244:247], v[36:39], 0
    ds_read_b64_tr_b16 a[246:247], v1 offset:4768
    v_exp_f32 v27, v27
    v_mfma_f32_16x16x32_bf16 v[148:151], a[248:251], v[36:39], 0
    ds_read_b64_tr_b16 a[244:245], v1 offset:4256
    ds_read_b64_tr_b16 a[248:249], v1 offset:4288
    ds_read_b64_tr_b16 a[250:251], v1 offset:4800
    v_mfma_f32_16x16x32_bf16 v[152:155], a[252:255], v[36:39], 0
    ds_read_b64_tr_b16 a[252:253], v1 offset:4320
    v_exp_f32 v32, v32
    v_mfma_f32_16x16x32_bf16 v[20:23], a[192:195], v[236:239], v[4:7]
    ds_read_b64_tr_b16 a[254:255], v1 offset:4832
    ds_read_b128 a[192:195], v0 offset:8448
    v_cvt_pk_bf16_f32 v40, v24, v25
    v_mfma_f32_16x16x32_bf16 v[20:23], a[196:199], v[240:243], v[20:23]
    ds_read_b128 a[196:199], v0 offset:8512
    v_exp_f32 v33, v33
    v_mfma_f32_16x16x32_bf16 v[20:23], a[200:203], v[244:247], v[20:23]
    ds_read_b128 a[200:203], v0 offset:12672
    v_cvt_pk_bf16_f32 v41, v26, v27
    v_cvt_pk_bf16_f32 v42, v32, v33
    v_mfma_f32_16x16x32_bf16 v[20:23], a[204:207], v[248:251], v[20:23]
    ds_read_b128 a[204:207], v0 offset:12736
    v_exp_f32 v34, v34
    v_mfma_f32_16x16x32_bf16 v[28:31], a[208:211], v[236:239], v[4:7]
    ds_read_b128 a[208:211], v0 offset:8960
    v_add_f32 v15, v15, v25
    v_add_f32 v15, v15, v26
    v_mfma_f32_16x16x32_bf16 v[28:31], a[212:215], v[240:243], v[28:31]
    ds_read_b128 a[212:215], v0 offset:9024
    v_exp_f32 v35, v35
    v_mfma_f32_16x16x32_bf16 v[28:31], a[216:219], v[244:247], v[28:31]
    ds_read_b128 a[216:219], v0 offset:13184
    v_add_f32 v15, v15, v33
    v_cvt_pk_bf16_f32 v43, v34, v35
    v_mfma_f32_16x16x32_bf16 v[28:31], a[220:223], v[248:251], v[28:31]
    s_waitcnt lgkmcnt(15)
    ds_read_b128 a[220:223], v0 offset:13248
    v_exp_f32 v20, v20
    v_mfma_f32_16x16x32_bf16 v[76:79], a[224:227], v[40:43], v[76:79]
    v_add_f32 v15, v15, v27
    v_add_f32 v15, v15, v34
    v_add_f32 v15, v15, v35
    v_mfma_f32_16x16x32_bf16 v[80:83], a[228:231], v[40:43], v[80:83]
    v_exp_f32 v21, v21
    v_mfma_f32_16x16x32_bf16 v[84:87], a[232:235], v[40:43], v[84:87]
    v_add_f32 v16, v16, v20
    v_cvt_pk_bf16_f32 v36, v20, v21
    v_mfma_f32_16x16x32_bf16 v[88:91], a[236:239], v[40:43], v[88:91]
    s_waitcnt lgkmcnt(14)
    v_exp_f32 v22, v22
    v_mfma_f32_16x16x32_bf16 v[92:95], a[240:243], v[40:43], v[92:95]
    s_waitcnt lgkmcnt(12)
    v_add_f32 v15, v15, v32
    v_add_f32 v16, v16, v21
    v_mfma_f32_16x16x32_bf16 v[96:99], a[244:247], v[40:43], v[96:99]
    s_waitcnt lgkmcnt(10)
    v_exp_f32 v23, v23
    v_mfma_f32_16x16x32_bf16 v[100:103], a[248:251], v[40:43], v[100:103]
    s_waitcnt lgkmcnt(8)
    v_add_f32 v16, v16, v22
    v_cvt_pk_bf16_f32 v37, v22, v23
    v_mfma_f32_16x16x32_bf16 v[104:107], a[252:255], v[40:43], v[104:107]
    s_waitcnt lgkmcnt(7)
    v_exp_f32 v28, v28
    v_mfma_f32_16x16x32_bf16 v[24:27], a[192:195], v[108:111], v[4:7]
    s_waitcnt lgkmcnt(6)
    v_add_f32 v16, v16, v23
    v_add_f32 v16, v16, v28
    v_mfma_f32_16x16x32_bf16 v[24:27], a[196:199], v[112:115], v[24:27]
    s_waitcnt lgkmcnt(5)
    v_exp_f32 v29, v29
    v_mfma_f32_16x16x32_bf16 v[24:27], a[200:203], v[116:119], v[24:27]
    s_waitcnt lgkmcnt(4)
    v_cvt_pk_bf16_f32 v38, v28, v29
    v_add_u32 v0, s29, v0
    v_mfma_f32_16x16x32_bf16 v[24:27], a[204:207], v[120:123], v[24:27]
    s_waitcnt lgkmcnt(3)
    v_exp_f32 v30, v30
    v_mfma_f32_16x16x32_bf16 v[32:35], a[208:211], v[108:111], v[4:7]
    s_waitcnt lgkmcnt(2)
    v_add_f32 v16, v16, v29
    v_add_f32 v16, v16, v30
    v_mfma_f32_16x16x32_bf16 v[32:35], a[212:215], v[112:115], v[32:35]
    s_waitcnt lgkmcnt(1)
    v_exp_f32 v31, v31
    v_mfma_f32_16x16x32_bf16 v[32:35], a[216:219], v[116:119], v[32:35]
    s_waitcnt lgkmcnt(0)
    v_add_f32 v16, v16, v31
    v_cvt_pk_bf16_f32 v39, v30, v31
    v_mfma_f32_16x16x32_bf16 v[32:35], a[220:223], v[120:123], v[32:35]
    v_exp_f32 v24, v24
    v_mfma_f32_16x16x32_bf16 v[124:127], a[224:227], v[36:39], v[124:127]
    ds_read_b64_tr_b16 a[224:225], v1 offset:8448
    ds_read_b64_tr_b16 a[226:227], v1 offset:8960
    v_add_f32 v15, v15, v24
    v_mfma_f32_16x16x32_bf16 v[128:131], a[228:231], v[36:39], v[128:131]
    ds_read_b64_tr_b16 a[228:229], v1 offset:8480
    v_exp_f32 v25, v25
    v_mfma_f32_16x16x32_bf16 v[132:135], a[232:235], v[36:39], v[132:135]
    ds_read_b64_tr_b16 a[230:231], v1 offset:8992
    ds_read_b64_tr_b16 a[232:233], v1 offset:8512
    ds_read_b64_tr_b16 a[234:235], v1 offset:9024
    v_mfma_f32_16x16x32_bf16 v[136:139], a[236:239], v[36:39], v[136:139]
    ds_read_b64_tr_b16 a[238:239], v1 offset:9056
    v_exp_f32 v26, v26
    v_mfma_f32_16x16x32_bf16 v[140:143], a[240:243], v[36:39], v[140:143]
    ds_read_b64_tr_b16 a[236:237], v1 offset:8544
    ds_read_b64_tr_b16 a[240:241], v1 offset:12672
    ds_read_b64_tr_b16 a[242:243], v1 offset:13184
    v_mfma_f32_16x16x32_bf16 v[144:147], a[244:247], v[36:39], v[144:147]
    s_waitcnt vmcnt(0)
    ds_read_b64_tr_b16 a[244:245], v1 offset:12704
    v_exp_f32 v27, v27
    v_mfma_f32_16x16x32_bf16 v[148:151], a[248:251], v[36:39], v[148:151]
    s_barrier
    ds_read_b64_tr_b16 a[246:247], v1 offset:13216
    ds_read_b64_tr_b16 a[248:249], v1 offset:12736
    ds_read_b64_tr_b16 a[250:251], v1 offset:13248
    s_lshl_b32 s37, s4, 9
    s_add_u32 s37, s37, 32768
    s_add_u32 m0, s35, 25344
    s_nop 0
    buffer_load_dwordx4 v3, s[12:15], s37 offen nt lds
    s_add_u32 m0, s35, 29440
    s_nop 0
    buffer_load_dwordx4 v3, s[12:15], s37 offen offset:128 nt lds
    s_add_u32 m0, s35, 59136
    s_nop 0
    buffer_load_dwordx4 v3, s[16:19], s37 offen nt lds
    s_add_u32 m0, s35, 63232
    s_nop 0
    buffer_load_dwordx4 v3, s[16:19], s37 offen offset:128 nt lds
    s_lshl_b32 s37, s4, 9
    s_add_u32 s37, s37, 40960
    s_add_u32 m0, s35, 0
    s_nop 0
    buffer_load_dwordx4 v3, s[12:15], s37 offen nt lds
    s_add_u32 m0, s35, 4096
    s_nop 0
    buffer_load_dwordx4 v3, s[12:15], s37 offen offset:128 nt lds
    s_add_u32 m0, s35, 33792
    s_nop 0
    buffer_load_dwordx4 v3, s[16:19], s37 offen nt lds
    s_add_u32 m0, s35, 37888
    s_nop 0
    buffer_load_dwordx4 v3, s[16:19], s37 offen offset:128 nt lds
    v_mfma_f32_16x16x32_bf16 v[152:155], a[252:255], v[36:39], v[152:155]
    ds_read_b64_tr_b16 a[252:253], v1 offset:12768
    v_exp_f32 v32, v32
    v_mfma_f32_16x16x32_bf16 v[20:23], a[192:195], v[236:239], v[4:7]
    ds_read_b128 a[192:195], v0 offset:0
    ds_read_b64_tr_b16 a[254:255], v1 offset:13280
    v_cvt_pk_bf16_f32 v41, v26, v27
    v_mfma_f32_16x16x32_bf16 v[20:23], a[196:199], v[240:243], v[20:23]
    ds_read_b128 a[196:199], v0 offset:64
    v_exp_f32 v33, v33
    v_mfma_f32_16x16x32_bf16 v[20:23], a[200:203], v[244:247], v[20:23]
    ds_read_b128 a[200:203], v0 offset:4224
    v_cvt_pk_bf16_f32 v40, v24, v25
    v_cvt_pk_bf16_f32 v42, v32, v33
    v_mfma_f32_16x16x32_bf16 v[20:23], a[204:207], v[248:251], v[20:23]
    v_exp_f32 v34, v34
    v_mfma_f32_16x16x32_bf16 v[28:31], a[208:211], v[236:239], v[4:7]
    ds_read_b128 a[204:207], v0 offset:4288
    ds_read_b128 a[208:211], v0 offset:512
    v_add_f32 v15, v15, v25
    v_mfma_f32_16x16x32_bf16 v[28:31], a[212:215], v[240:243], v[28:31]
    ds_read_b128 a[212:215], v0 offset:576
    v_exp_f32 v35, v35
    v_mfma_f32_16x16x32_bf16 v[28:31], a[216:219], v[244:247], v[28:31]
    ds_read_b128 a[216:219], v0 offset:4736
    v_add_f32 v15, v15, v34
    v_cvt_pk_bf16_f32 v43, v34, v35
    v_mfma_f32_16x16x32_bf16 v[28:31], a[220:223], v[248:251], v[28:31]
    s_waitcnt lgkmcnt(15)
    v_exp_f32 v20, v20
    v_mfma_f32_16x16x32_bf16 v[76:79], a[224:227], v[40:43], v[76:79]
    ds_read_b128 a[220:223], v0 offset:4800
    v_add_f32 v15, v15, v26
    v_add_f32 v15, v15, v35
    v_mfma_f32_16x16x32_bf16 v[80:83], a[228:231], v[40:43], v[80:83]
    v_exp_f32 v21, v21
    v_mfma_f32_16x16x32_bf16 v[84:87], a[232:235], v[40:43], v[84:87]
    v_add_f32 v15, v15, v33
    v_add_f32 v16, v16, v21
    v_cvt_pk_bf16_f32 v36, v20, v21
    v_mfma_f32_16x16x32_bf16 v[88:91], a[236:239], v[40:43], v[88:91]
    s_waitcnt lgkmcnt(14)
    v_exp_f32 v22, v22
    v_mfma_f32_16x16x32_bf16 v[92:95], a[240:243], v[40:43], v[92:95]
    s_waitcnt lgkmcnt(12)
    v_add_f32 v15, v15, v32
    v_add_f32 v16, v16, v20
    v_add_u32 v1, s29, v1
    v_mfma_f32_16x16x32_bf16 v[96:99], a[244:247], v[40:43], v[96:99]
    s_waitcnt lgkmcnt(10)
    v_exp_f32 v23, v23
    v_mfma_f32_16x16x32_bf16 v[100:103], a[248:251], v[40:43], v[100:103]
    s_waitcnt lgkmcnt(7)
    v_add_f32 v15, v15, v27
    v_cvt_pk_bf16_f32 v37, v22, v23
    v_mfma_f32_16x16x32_bf16 v[104:107], a[252:255], v[40:43], v[104:107]
    v_exp_f32 v28, v28
L_preloop:
    s_mov_b32 s30, 13
    .p2align 6
L_loop:
    v_mfma_f32_16x16x32_bf16 v[24:27], a[192:195], v[156:159], v[4:7]
    s_waitcnt lgkmcnt(6)
    v_add_f32 v16, v16, v22
    v_add_f32 v16, v16, v23
    v_mfma_f32_16x16x32_bf16 v[24:27], a[196:199], v[160:163], v[24:27]
    s_waitcnt lgkmcnt(5)
    v_exp_f32 v29, v29
    v_mfma_f32_16x16x32_bf16 v[24:27], a[200:203], v[164:167], v[24:27]
    s_waitcnt lgkmcnt(4)
    v_add_f32 v16, v16, v28
    v_cvt_pk_bf16_f32 v38, v28, v29
    v_mfma_f32_16x16x32_bf16 v[24:27], a[204:207], v[168:171], v[24:27]
    s_waitcnt lgkmcnt(3)
    v_exp_f32 v30, v30
    v_mfma_f32_16x16x32_bf16 v[32:35], a[208:211], v[156:159], v[4:7]
    s_waitcnt lgkmcnt(2)
    v_add_f32 v16, v16, v29
    v_add_f32 v16, v16, v30
    v_mfma_f32_16x16x32_bf16 v[32:35], a[212:215], v[160:163], v[32:35]
    s_waitcnt lgkmcnt(1)
    v_exp_f32 v31, v31
    v_mfma_f32_16x16x32_bf16 v[32:35], a[216:219], v[164:167], v[32:35]
    s_waitcnt lgkmcnt(0)
    v_add_f32 v16, v16, v31
    v_cvt_pk_bf16_f32 v39, v30, v31
    v_mfma_f32_16x16x32_bf16 v[32:35], a[220:223], v[168:171], v[32:35]
    v_exp_f32 v24, v24
    v_mfma_f32_16x16x32_bf16 v[124:127], a[224:227], v[36:39], v[124:127]
    ds_read_b64_tr_b16 a[224:225], v1 offset:0
    ds_read_b64_tr_b16 a[226:227], v1 offset:512
    v_mfma_f32_16x16x32_bf16 v[128:131], a[228:231], v[36:39], v[128:131]
    ds_read_b64_tr_b16 a[230:231], v1 offset:544
    v_exp_f32 v25, v25
    v_mfma_f32_16x16x32_bf16 v[132:135], a[232:235], v[36:39], v[132:135]
    ds_read_b64_tr_b16 a[228:229], v1 offset:32
    ds_read_b64_tr_b16 a[232:233], v1 offset:64
    ds_read_b64_tr_b16 a[234:235], v1 offset:576
    v_mfma_f32_16x16x32_bf16 v[136:139], a[236:239], v[36:39], v[136:139]
    ds_read_b64_tr_b16 a[238:239], v1 offset:608
    v_exp_f32 v26, v26
    v_mfma_f32_16x16x32_bf16 v[140:143], a[240:243], v[36:39], v[140:143]
    ds_read_b64_tr_b16 a[236:237], v1 offset:96
    ds_read_b64_tr_b16 a[240:241], v1 offset:4224
    ds_read_b64_tr_b16 a[242:243], v1 offset:4736
    v_mfma_f32_16x16x32_bf16 v[144:147], a[244:247], v[36:39], v[144:147]
    ds_read_b64_tr_b16 a[244:245], v1 offset:4256
    v_exp_f32 v27, v27
    v_mfma_f32_16x16x32_bf16 v[148:151], a[248:251], v[36:39], v[148:151]
    ds_read_b64_tr_b16 a[246:247], v1 offset:4768
    ds_read_b64_tr_b16 a[248:249], v1 offset:4288
    ds_read_b64_tr_b16 a[250:251], v1 offset:4800
    v_mfma_f32_16x16x32_bf16 v[152:155], a[252:255], v[36:39], v[152:155]
    v_exp_f32 v32, v32
    v_mfma_f32_16x16x32_bf16 v[20:23], a[192:195], v[172:175], v[4:7]
    ds_read_b64_tr_b16 a[252:253], v1 offset:4320
    ds_read_b64_tr_b16 a[254:255], v1 offset:4832
    v_mfma_f32_16x16x32_bf16 v[20:23], a[196:199], v[176:179], v[20:23]
    v_exp_f32 v33, v33
    v_mfma_f32_16x16x32_bf16 v[20:23], a[200:203], v[180:183], v[20:23]
    v_cvt_pk_bf16_f32 v41, v26, v27
    v_cvt_pk_bf16_f32 v42, v32, v33
    v_mfma_f32_16x16x32_bf16 v[20:23], a[204:207], v[184:187], v[20:23]
    s_add_u32 s27, s27, s29
    v_exp_f32 v34, v34
    v_mfma_f32_16x16x32_bf16 v[28:31], a[208:211], v[172:175], v[4:7]
    v_add_f32 v8, v8, v25
    v_cvt_pk_bf16_f32 v40, v24, v25
    v_mfma_f32_16x16x32_bf16 v[28:31], a[212:215], v[176:179], v[28:31]
    s_sub_u32 s28, s28, s29
    v_exp_f32 v35, v35
    v_mfma_f32_16x16x32_bf16 v[28:31], a[216:219], v[180:183], v[28:31]
    ds_read_b128 v[112:115], v2 offset:64
    v_cvt_pk_bf16_f32 v43, v34, v35
    v_mfma_f32_16x16x32_bf16 v[28:31], a[220:223], v[184:187], v[28:31]
    s_waitcnt lgkmcnt(15)
    s_sub_u32 s29, 0, s29
    v_exp_f32 v20, v20
    v_mfma_f32_16x16x32_bf16 a[0:3], a[224:227], v[40:43], a[0:3]
    s_waitcnt lgkmcnt(13)
    ds_read_b128 v[116:119], v2 offset:4224
    ds_read_b128 v[120:123], v2 offset:4288
    v_mfma_f32_16x16x32_bf16 a[4:7], a[228:231], v[40:43], a[4:7]
    s_waitcnt lgkmcnt(13)
    v_exp_f32 v21, v21
    v_mfma_f32_16x16x32_bf16 a[8:11], a[232:235], v[40:43], a[8:11]
    s_waitcnt lgkmcnt(11)
    ds_read_b128 v[108:111], v2 offset:0
    v_cvt_pk_bf16_f32 v36, v20, v21
    v_mfma_f32_16x16x32_bf16 a[12:15], a[236:239], v[40:43], a[12:15]
    s_waitcnt lgkmcnt(10)
    v_exp_f32 v22, v22
    v_mfma_f32_16x16x32_bf16 a[16:19], a[240:243], v[40:43], a[16:19]
    s_waitcnt lgkmcnt(8)
    v_add_f32 v8, v8, v26
    v_add_f32 v8, v8, v27
    v_mfma_f32_16x16x32_bf16 a[20:23], a[244:247], v[40:43], a[20:23]
    s_waitcnt lgkmcnt(6)
    v_exp_f32 v23, v23
    v_mfma_f32_16x16x32_bf16 a[24:27], a[248:251], v[40:43], a[24:27]
    s_waitcnt lgkmcnt(4)
    v_add_f32 v8, v8, v24
    v_cvt_pk_bf16_f32 v37, v22, v23
    v_mfma_f32_16x16x32_bf16 a[28:31], a[252:255], v[40:43], a[28:31]
    v_exp_f32 v28, v28
    v_mfma_f32_16x16x32_bf16 v[24:27], a[192:195], v[188:191], v[4:7]
    v_add_f32 v8, v8, v33
    v_add_f32 v8, v8, v35
    v_mfma_f32_16x16x32_bf16 v[24:27], a[196:199], v[192:195], v[24:27]
    v_exp_f32 v29, v29
    v_mfma_f32_16x16x32_bf16 v[24:27], a[200:203], v[196:199], v[24:27]
    v_add_f32 v8, v8, v32
    v_add_f32 v8, v8, v34
    v_mfma_f32_16x16x32_bf16 v[24:27], a[204:207], v[200:203], v[24:27]
    v_exp_f32 v30, v30
    v_mfma_f32_16x16x32_bf16 v[32:35], a[208:211], v[188:191], v[4:7]
    v_add_f32 v9, v9, v23
    v_cvt_pk_bf16_f32 v38, v28, v29
    v_mfma_f32_16x16x32_bf16 v[32:35], a[212:215], v[192:195], v[32:35]
    v_exp_f32 v31, v31
    v_mfma_f32_16x16x32_bf16 v[32:35], a[216:219], v[196:199], v[32:35]
    v_add_f32 v9, v9, v30
    v_cvt_pk_bf16_f32 v39, v30, v31
    v_mfma_f32_16x16x32_bf16 v[32:35], a[220:223], v[200:203], v[32:35]
    v_exp_f32 v24, v24
    v_mfma_f32_16x16x32_bf16 a[32:35], a[224:227], v[36:39], a[32:35]
    v_add_f32 v9, v9, v20
    v_add_f32 v9, v9, v29
    v_mfma_f32_16x16x32_bf16 a[36:39], a[228:231], v[36:39], a[36:39]
    v_exp_f32 v25, v25
    v_mfma_f32_16x16x32_bf16 a[40:43], a[232:235], v[36:39], a[40:43]
    v_add_f32 v9, v9, v22
    v_cvt_pk_bf16_f32 v40, v24, v25
    v_mfma_f32_16x16x32_bf16 a[44:47], a[236:239], v[36:39], a[44:47]
    v_exp_f32 v26, v26
    v_mfma_f32_16x16x32_bf16 a[48:51], a[240:243], v[36:39], a[48:51]
    v_add_f32 v9, v9, v21
    v_add_f32 v10, v10, v25
    v_mfma_f32_16x16x32_bf16 a[52:55], a[244:247], v[36:39], a[52:55]
    v_exp_f32 v27, v27
    v_mfma_f32_16x16x32_bf16 a[56:59], a[248:251], v[36:39], a[56:59]
    v_add_f32 v9, v9, v28
    v_cvt_pk_bf16_f32 v41, v26, v27
    v_mfma_f32_16x16x32_bf16 a[60:63], a[252:255], v[36:39], a[60:63]
    s_waitcnt lgkmcnt(0)
    v_exp_f32 v32, v32
    v_mfma_f32_16x16x32_bf16 v[20:23], a[192:195], v[108:111], v[4:7]
    v_add_f32 v9, v9, v31
    v_add_f32 v10, v10, v27
    v_mfma_f32_16x16x32_bf16 v[20:23], a[196:199], v[112:115], v[20:23]
    v_exp_f32 v33, v33
    v_mfma_f32_16x16x32_bf16 v[20:23], a[200:203], v[116:119], v[20:23]
    v_add_f32 v10, v10, v24
    v_cvt_pk_bf16_f32 v42, v32, v33
    v_mfma_f32_16x16x32_bf16 v[20:23], a[204:207], v[120:123], v[20:23]
    s_add_u32 m0, s28, 8448
    v_exp_f32 v34, v34
    v_mfma_f32_16x16x32_bf16 v[28:31], a[208:211], v[108:111], v[4:7]
    buffer_load_dwordx4 v3, s[12:15], s26 offen nt lds
    v_mfma_f32_16x16x32_bf16 v[28:31], a[212:215], v[112:115], v[28:31]
    v_exp_f32 v35, v35
    v_mfma_f32_16x16x32_bf16 v[28:31], a[216:219], v[116:119], v[28:31]
    ds_read_b128 v[116:119], v2 offset:4736
    v_cvt_pk_bf16_f32 v43, v34, v35
    v_mfma_f32_16x16x32_bf16 v[28:31], a[220:223], v[120:123], v[28:31]
    v_exp_f32 v20, v20
    v_mfma_f32_16x16x32_bf16 a[64:67], a[224:227], v[40:43], a[64:67]
    ds_read_b128 v[108:111], v2 offset:512
    ds_read_b128 v[112:115], v2 offset:576
    v_mfma_f32_16x16x32_bf16 a[68:71], a[228:231], v[40:43], a[68:71]
    v_exp_f32 v21, v21
    v_mfma_f32_16x16x32_bf16 a[72:75], a[232:235], v[40:43], a[72:75]
    ds_read_b128 v[120:123], v2 offset:4800
    v_cvt_pk_bf16_f32 v36, v20, v21
    v_mfma_f32_16x16x32_bf16 a[76:79], a[236:239], v[40:43], a[76:79]
    s_add_u32 m0, s28, 12544
    v_exp_f32 v22, v22
    v_mfma_f32_16x16x32_bf16 a[80:83], a[240:243], v[40:43], a[80:83]
    buffer_load_dwordx4 v3, s[12:15], s26 offen offset:128 nt lds
    v_mfma_f32_16x16x32_bf16 a[84:87], a[244:247], v[40:43], a[84:87]
    v_exp_f32 v23, v23
    v_mfma_f32_16x16x32_bf16 a[88:91], a[248:251], v[40:43], a[88:91]
    v_add_f32 v10, v10, v26
    v_cvt_pk_bf16_f32 v37, v22, v23
    v_mfma_f32_16x16x32_bf16 a[92:95], a[252:255], v[40:43], a[92:95]
    v_exp_f32 v28, v28
    v_mfma_f32_16x16x32_bf16 v[24:27], a[192:195], v[204:207], v[4:7]
    v_add_f32 v10, v10, v33
    v_add_f32 v10, v10, v34
    v_mfma_f32_16x16x32_bf16 v[24:27], a[196:199], v[208:211], v[24:27]
    v_exp_f32 v29, v29
    v_mfma_f32_16x16x32_bf16 v[24:27], a[200:203], v[212:215], v[24:27]
    v_add_f32 v10, v10, v32
    v_add_f32 v10, v10, v35
    v_mfma_f32_16x16x32_bf16 v[24:27], a[204:207], v[216:219], v[24:27]
    v_exp_f32 v30, v30
    v_mfma_f32_16x16x32_bf16 v[32:35], a[208:211], v[204:207], v[4:7]
    v_add_f32 v11, v11, v23
    v_cvt_pk_bf16_f32 v38, v28, v29
    v_mfma_f32_16x16x32_bf16 v[32:35], a[212:215], v[208:211], v[32:35]
    v_exp_f32 v31, v31
    v_mfma_f32_16x16x32_bf16 v[32:35], a[216:219], v[212:215], v[32:35]
    v_add_f32 v11, v11, v20
    v_cvt_pk_bf16_f32 v39, v30, v31
    v_mfma_f32_16x16x32_bf16 v[32:35], a[220:223], v[216:219], v[32:35]
    v_exp_f32 v24, v24
    v_mfma_f32_16x16x32_bf16 a[96:99], a[224:227], v[36:39], a[96:99]
    v_add_f32 v11, v11, v21
    v_add_f32 v11, v11, v29
    v_mfma_f32_16x16x32_bf16 a[100:103], a[228:231], v[36:39], a[100:103]
    v_exp_f32 v25, v25
    v_mfma_f32_16x16x32_bf16 a[104:107], a[232:235], v[36:39], a[104:107]
    v_add_f32 v11, v11, v22
    v_cvt_pk_bf16_f32 v40, v24, v25
    v_mfma_f32_16x16x32_bf16 a[108:111], a[236:239], v[36:39], a[108:111]
    v_exp_f32 v26, v26
    v_mfma_f32_16x16x32_bf16 a[112:115], a[240:243], v[36:39], a[112:115]
    v_add_f32 v11, v11, v31
    v_add_f32 v12, v12, v25
    v_mfma_f32_16x16x32_bf16 a[116:119], a[244:247], v[36:39], a[116:119]
    v_exp_f32 v27, v27
    v_mfma_f32_16x16x32_bf16 a[120:123], a[248:251], v[36:39], a[120:123]
    v_add_f32 v11, v11, v30
    v_cvt_pk_bf16_f32 v41, v26, v27
    v_mfma_f32_16x16x32_bf16 a[124:127], a[252:255], v[36:39], a[124:127]
    s_waitcnt lgkmcnt(2)
    v_exp_f32 v32, v32
    v_mfma_f32_16x16x32_bf16 v[20:23], a[192:195], v[108:111], v[4:7]
    s_waitcnt lgkmcnt(1)
    v_add_f32 v11, v11, v28
    v_add_f32 v12, v12, v27
    v_mfma_f32_16x16x32_bf16 v[20:23], a[196:199], v[112:115], v[20:23]
    v_exp_f32 v33, v33
    v_mfma_f32_16x16x32_bf16 v[20:23], a[200:203], v[116:119], v[20:23]
    s_waitcnt lgkmcnt(0)
    v_add_f32 v12, v12, v24
    v_cvt_pk_bf16_f32 v42, v32, v33
    v_mfma_f32_16x16x32_bf16 v[20:23], a[204:207], v[120:123], v[20:23]
    s_add_u32 m0, s28, 42240
    v_exp_f32 v34, v34
    v_mfma_f32_16x16x32_bf16 v[28:31], a[208:211], v[108:111], v[4:7]
    buffer_load_dwordx4 v3, s[16:19], s26 offen nt lds
    v_mfma_f32_16x16x32_bf16 v[28:31], a[212:215], v[112:115], v[28:31]
    v_exp_f32 v35, v35
    v_mfma_f32_16x16x32_bf16 v[28:31], a[216:219], v[116:119], v[28:31]
    ds_read_b128 v[108:111], v2 offset:8448
    v_cvt_pk_bf16_f32 v43, v34, v35
    v_mfma_f32_16x16x32_bf16 v[28:31], a[220:223], v[120:123], v[28:31]
    v_exp_f32 v20, v20
    v_mfma_f32_16x16x32_bf16 a[128:131], a[224:227], v[40:43], a[128:131]
    ds_read_b128 v[112:115], v2 offset:8512
    ds_read_b128 v[116:119], v2 offset:12672
    v_mfma_f32_16x16x32_bf16 a[132:135], a[228:231], v[40:43], a[132:135]
    v_exp_f32 v21, v21
    v_mfma_f32_16x16x32_bf16 a[136:139], a[232:235], v[40:43], a[136:139]
    ds_read_b128 v[120:123], v2 offset:12736
    v_cvt_pk_bf16_f32 v36, v20, v21
    v_mfma_f32_16x16x32_bf16 a[140:143], a[236:239], v[40:43], a[140:143]
    s_add_u32 m0, s28, 46336
    v_exp_f32 v22, v22
    v_mfma_f32_16x16x32_bf16 a[144:147], a[240:243], v[40:43], a[144:147]
    buffer_load_dwordx4 v3, s[16:19], s26 offen offset:128 nt lds
    v_mfma_f32_16x16x32_bf16 a[148:151], a[244:247], v[40:43], a[148:151]
    s_add_u32 s26, s26, 8192
    v_exp_f32 v23, v23
    v_mfma_f32_16x16x32_bf16 a[152:155], a[248:251], v[40:43], a[152:155]
    v_add_f32 v12, v12, v26
    v_cvt_pk_bf16_f32 v37, v22, v23
    v_mfma_f32_16x16x32_bf16 a[156:159], a[252:255], v[40:43], a[156:159]
    v_exp_f32 v28, v28
    v_mfma_f32_16x16x32_bf16 v[24:27], a[192:195], v[220:223], v[4:7]
    v_add_f32 v12, v12, v33
    v_add_f32 v12, v12, v35
    v_mfma_f32_16x16x32_bf16 v[24:27], a[196:199], v[224:227], v[24:27]
    v_exp_f32 v29, v29
    v_mfma_f32_16x16x32_bf16 v[24:27], a[200:203], v[228:231], v[24:27]
    v_add_f32 v12, v12, v32
    v_add_f32 v12, v12, v34
    v_mfma_f32_16x16x32_bf16 v[24:27], a[204:207], v[232:235], v[24:27]
    v_exp_f32 v30, v30
    v_mfma_f32_16x16x32_bf16 v[32:35], a[208:211], v[220:223], v[4:7]
    v_add_f32 v13, v13, v30
    v_cvt_pk_bf16_f32 v38, v28, v29
    v_mfma_f32_16x16x32_bf16 v[32:35], a[212:215], v[224:227], v[32:35]
    v_exp_f32 v31, v31
    v_mfma_f32_16x16x32_bf16 v[32:35], a[216:219], v[228:231], v[32:35]
    v_add_f32 v13, v13, v31
    v_cvt_pk_bf16_f32 v39, v30, v31
    v_mfma_f32_16x16x32_bf16 v[32:35], a[220:223], v[232:235], v[32:35]
    v_exp_f32 v24, v24
    v_mfma_f32_16x16x32_bf16 a[160:163], a[224:227], v[36:39], a[160:163]
    v_add_f32 v13, v13, v21
    v_add_f32 v13, v13, v22
    v_mfma_f32_16x16x32_bf16 a[164:167], a[228:231], v[36:39], a[164:167]
    v_exp_f32 v25, v25
    v_mfma_f32_16x16x32_bf16 a[168:171], a[232:235], v[36:39], a[168:171]
    v_add_f32 v14, v14, v25
    v_cvt_pk_bf16_f32 v40, v24, v25
    v_mfma_f32_16x16x32_bf16 a[172:175], a[236:239], v[36:39], a[172:175]
    v_exp_f32 v26, v26
    v_mfma_f32_16x16x32_bf16 a[176:179], a[240:243], v[36:39], a[176:179]
    v_add_f32 v13, v13, v23
    v_add_f32 v13, v13, v29
    v_mfma_f32_16x16x32_bf16 a[180:183], a[244:247], v[36:39], a[180:183]
    v_exp_f32 v27, v27
    v_mfma_f32_16x16x32_bf16 a[184:187], a[248:251], v[36:39], a[184:187]
    v_add_f32 v13, v13, v20
    v_cvt_pk_bf16_f32 v41, v26, v27
    v_mfma_f32_16x16x32_bf16 a[188:191], a[252:255], v[36:39], a[188:191]
    s_waitcnt lgkmcnt(3)
    v_exp_f32 v32, v32
    v_mfma_f32_16x16x32_bf16 v[20:23], a[192:195], v[108:111], v[4:7]
    s_waitcnt lgkmcnt(2)
    v_add_f32 v13, v13, v28
    v_add_f32 v14, v14, v32
    v_mfma_f32_16x16x32_bf16 v[20:23], a[196:199], v[112:115], v[20:23]
    s_waitcnt lgkmcnt(1)
    v_exp_f32 v33, v33
    v_mfma_f32_16x16x32_bf16 v[20:23], a[200:203], v[116:119], v[20:23]
    s_waitcnt lgkmcnt(0)
    v_add_f32 v14, v14, v33
    v_cvt_pk_bf16_f32 v42, v32, v33
    v_mfma_f32_16x16x32_bf16 v[20:23], a[204:207], v[120:123], v[20:23]
    v_exp_f32 v34, v34
    v_mfma_f32_16x16x32_bf16 v[28:31], a[208:211], v[108:111], v[4:7]
    v_add_f32 v14, v14, v26
    v_add_f32 v14, v14, v34
    v_mfma_f32_16x16x32_bf16 v[28:31], a[212:215], v[112:115], v[28:31]
    v_exp_f32 v35, v35
    v_mfma_f32_16x16x32_bf16 v[28:31], a[216:219], v[116:119], v[28:31]
    v_add_f32 v14, v14, v35
    v_cvt_pk_bf16_f32 v43, v34, v35
    v_mfma_f32_16x16x32_bf16 v[28:31], a[220:223], v[120:123], v[28:31]
    v_exp_f32 v20, v20
    v_mfma_f32_16x16x32_bf16 v[44:47], a[224:227], v[40:43], v[44:47]
    v_add_f32 v14, v14, v24
    v_add_f32 v15, v15, v20
    v_mfma_f32_16x16x32_bf16 v[48:51], a[228:231], v[40:43], v[48:51]
    v_exp_f32 v21, v21
    v_mfma_f32_16x16x32_bf16 v[52:55], a[232:235], v[40:43], v[52:55]
    v_add_f32 v15, v15, v21
    v_cvt_pk_bf16_f32 v36, v20, v21
    v_mfma_f32_16x16x32_bf16 v[56:59], a[236:239], v[40:43], v[56:59]
    v_exp_f32 v22, v22
    v_mfma_f32_16x16x32_bf16 v[60:63], a[240:243], v[40:43], v[60:63]
    v_add_f32 v14, v14, v27
    v_add_f32 v15, v15, v22
    v_mfma_f32_16x16x32_bf16 v[64:67], a[244:247], v[40:43], v[64:67]
    s_waitcnt vmcnt(8)
    v_exp_f32 v23, v23
    v_mfma_f32_16x16x32_bf16 v[68:71], a[248:251], v[40:43], v[68:71]
    s_barrier
    v_add_f32 v15, v15, v23
    v_cvt_pk_bf16_f32 v37, v22, v23
    v_mfma_f32_16x16x32_bf16 v[72:75], a[252:255], v[40:43], v[72:75]
    v_exp_f32 v28, v28
    v_mfma_f32_16x16x32_bf16 v[24:27], a[192:195], v[236:239], v[4:7]
    ds_read_b128 a[192:195], v0 offset:8448
    v_add_f32 v15, v15, v28
    v_mfma_f32_16x16x32_bf16 v[24:27], a[196:199], v[240:243], v[24:27]
    ds_read_b128 a[196:199], v0 offset:8512
    v_exp_f32 v29, v29
    v_mfma_f32_16x16x32_bf16 v[24:27], a[200:203], v[244:247], v[24:27]
    ds_read_b128 a[200:203], v0 offset:12672
    v_cvt_pk_bf16_f32 v38, v28, v29
    v_mfma_f32_16x16x32_bf16 v[24:27], a[204:207], v[248:251], v[24:27]
    v_exp_f32 v30, v30
    v_mfma_f32_16x16x32_bf16 v[32:35], a[208:211], v[236:239], v[4:7]
    ds_read_b128 a[204:207], v0 offset:12736
    ds_read_b128 a[208:211], v0 offset:8960
    v_mfma_f32_16x16x32_bf16 v[32:35], a[212:215], v[240:243], v[32:35]
    ds_read_b128 a[212:215], v0 offset:9024
    v_exp_f32 v31, v31
    v_mfma_f32_16x16x32_bf16 v[32:35], a[216:219], v[244:247], v[32:35]
    ds_read_b128 a[216:219], v0 offset:13184
    v_cvt_pk_bf16_f32 v39, v30, v31
    v_mfma_f32_16x16x32_bf16 v[32:35], a[220:223], v[248:251], v[32:35]
    v_exp_f32 v24, v24
    v_mfma_f32_16x16x32_bf16 v[76:79], a[224:227], v[36:39], v[76:79]
    ds_read_b128 a[220:223], v0 offset:13248
    v_add_f32 v15, v15, v29
    v_mfma_f32_16x16x32_bf16 v[80:83], a[228:231], v[36:39], v[80:83]
    v_exp_f32 v25, v25
    v_mfma_f32_16x16x32_bf16 v[84:87], a[232:235], v[36:39], v[84:87]
    v_add_f32 v16, v16, v25
    v_cvt_pk_bf16_f32 v40, v24, v25
    v_mfma_f32_16x16x32_bf16 v[88:91], a[236:239], v[36:39], v[88:91]
    v_exp_f32 v26, v26
    v_mfma_f32_16x16x32_bf16 v[92:95], a[240:243], v[36:39], v[92:95]
    v_add_f32 v15, v15, v30
    v_add_f32 v16, v16, v24
    v_mfma_f32_16x16x32_bf16 v[96:99], a[244:247], v[36:39], v[96:99]
    v_exp_f32 v27, v27
    v_mfma_f32_16x16x32_bf16 v[100:103], a[248:251], v[36:39], v[100:103]
    v_add_f32 v16, v16, v26
    v_cvt_pk_bf16_f32 v41, v26, v27
    v_mfma_f32_16x16x32_bf16 v[104:107], a[252:255], v[36:39], v[104:107]
    s_cmp_eq_u32 s30, 0
    s_waitcnt lgkmcnt(7)
    v_exp_f32 v32, v32
    s_cbranch_scc1 L_tail
    v_mfma_f32_16x16x32_bf16 v[20:23], a[192:195], v[156:159], v[4:7]
    s_waitcnt lgkmcnt(6)
    v_add_f32 v15, v15, v31
    v_add_f32 v16, v16, v27
    v_mfma_f32_16x16x32_bf16 v[20:23], a[196:199], v[160:163], v[20:23]
    s_waitcnt lgkmcnt(5)
    v_exp_f32 v33, v33
    v_mfma_f32_16x16x32_bf16 v[20:23], a[200:203], v[164:167], v[20:23]
    s_waitcnt lgkmcnt(4)
    v_add_f32 v16, v16, v32
    v_cvt_pk_bf16_f32 v42, v32, v33
    v_mfma_f32_16x16x32_bf16 v[20:23], a[204:207], v[168:171], v[20:23]
    s_waitcnt lgkmcnt(3)
    v_exp_f32 v34, v34
    v_mfma_f32_16x16x32_bf16 v[28:31], a[208:211], v[156:159], v[4:7]
    s_waitcnt lgkmcnt(2)
    v_add_f32 v16, v16, v33
    v_add_f32 v16, v16, v34
    v_mfma_f32_16x16x32_bf16 v[28:31], a[212:215], v[160:163], v[28:31]
    s_waitcnt lgkmcnt(1)
    v_exp_f32 v35, v35
    v_mfma_f32_16x16x32_bf16 v[28:31], a[216:219], v[164:167], v[28:31]
    s_waitcnt lgkmcnt(0)
    v_add_f32 v16, v16, v35
    v_cvt_pk_bf16_f32 v43, v34, v35
    v_mfma_f32_16x16x32_bf16 v[28:31], a[220:223], v[168:171], v[28:31]
    v_exp_f32 v20, v20
    v_mfma_f32_16x16x32_bf16 v[124:127], a[224:227], v[40:43], v[124:127]
    ds_read_b64_tr_b16 a[224:225], v1 offset:8448
    ds_read_b64_tr_b16 a[226:227], v1 offset:8960
    v_mfma_f32_16x16x32_bf16 v[128:131], a[228:231], v[40:43], v[128:131]
    ds_read_b64_tr_b16 a[228:229], v1 offset:8480
    v_exp_f32 v21, v21
    v_mfma_f32_16x16x32_bf16 v[132:135], a[232:235], v[40:43], v[132:135]
    ds_read_b64_tr_b16 a[230:231], v1 offset:8992
    ds_read_b64_tr_b16 a[232:233], v1 offset:8512
    ds_read_b64_tr_b16 a[234:235], v1 offset:9024
    v_mfma_f32_16x16x32_bf16 v[136:139], a[236:239], v[40:43], v[136:139]
    ds_read_b64_tr_b16 a[236:237], v1 offset:8544
    v_exp_f32 v22, v22
    v_mfma_f32_16x16x32_bf16 v[140:143], a[240:243], v[40:43], v[140:143]
    ds_read_b64_tr_b16 a[238:239], v1 offset:9056
    ds_read_b64_tr_b16 a[240:241], v1 offset:12672
    ds_read_b64_tr_b16 a[242:243], v1 offset:13184
    v_mfma_f32_16x16x32_bf16 v[144:147], a[244:247], v[40:43], v[144:147]
    ds_read_b64_tr_b16 a[246:247], v1 offset:13216
    v_exp_f32 v23, v23
    v_mfma_f32_16x16x32_bf16 v[148:151], a[248:251], v[40:43], v[148:151]
    ds_read_b64_tr_b16 a[244:245], v1 offset:12704
    ds_read_b64_tr_b16 a[248:249], v1 offset:12736
    ds_read_b64_tr_b16 a[250:251], v1 offset:13248
    v_mfma_f32_16x16x32_bf16 v[152:155], a[252:255], v[40:43], v[152:155]
    ds_read_b64_tr_b16 a[254:255], v1 offset:13280
    v_exp_f32 v28, v28
    v_mfma_f32_16x16x32_bf16 v[24:27], a[192:195], v[172:175], v[4:7]
    ds_read_b64_tr_b16 a[252:253], v1 offset:12768
    v_cvt_pk_bf16_f32 v36, v20, v21
    v_mfma_f32_16x16x32_bf16 v[24:27], a[196:199], v[176:179], v[24:27]
    v_exp_f32 v29, v29
    v_mfma_f32_16x16x32_bf16 v[24:27], a[200:203], v[180:183], v[24:27]
    v_cvt_pk_bf16_f32 v37, v22, v23
    v_cvt_pk_bf16_f32 v38, v28, v29
    v_mfma_f32_16x16x32_bf16 v[24:27], a[204:207], v[184:187], v[24:27]
    v_exp_f32 v30, v30
    v_mfma_f32_16x16x32_bf16 v[32:35], a[208:211], v[172:175], v[4:7]
    v_add_f32 v8, v8, v28
    v_add_f32 v8, v8, v29
    v_mfma_f32_16x16x32_bf16 v[32:35], a[212:215], v[176:179], v[32:35]
    v_exp_f32 v31, v31
    v_mfma_f32_16x16x32_bf16 v[32:35], a[216:219], v[180:183], v[32:35]
    ds_read_b128 v[112:115], v2 offset:64
    ds_read_b128 v[120:123], v2 offset:4288
    v_cvt_pk_bf16_f32 v39, v30, v31
    v_mfma_f32_16x16x32_bf16 v[32:35], a[220:223], v[184:187], v[32:35]
    s_waitcnt lgkmcnt(15)
    v_exp_f32 v24, v24
    v_mfma_f32_16x16x32_bf16 a[0:3], a[224:227], v[36:39], a[0:3]
    s_waitcnt lgkmcnt(14)
    ds_read_b128 v[108:111], v2 offset:0
    ds_read_b128 v[116:119], v2 offset:4224
    v_mfma_f32_16x16x32_bf16 a[4:7], a[228:231], v[36:39], a[4:7]
    s_waitcnt lgkmcnt(14)
    v_exp_f32 v25, v25
    v_mfma_f32_16x16x32_bf16 a[8:11], a[232:235], v[36:39], a[8:11]
    s_waitcnt lgkmcnt(12)
    v_add_f32 v8, v8, v22
    v_cvt_pk_bf16_f32 v40, v24, v25
    v_mfma_f32_16x16x32_bf16 a[12:15], a[236:239], v[36:39], a[12:15]
    s_waitcnt lgkmcnt(10)
    v_exp_f32 v26, v26
    v_mfma_f32_16x16x32_bf16 a[16:19], a[240:243], v[36:39], a[16:19]
    s_waitcnt lgkmcnt(8)
    v_add_f32 v8, v8, v21
    v_add_f32 v8, v8, v23
    v_mfma_f32_16x16x32_bf16 a[20:23], a[244:247], v[36:39], a[20:23]
    s_waitcnt lgkmcnt(6)
    v_exp_f32 v27, v27
    v_mfma_f32_16x16x32_bf16 a[24:27], a[248:251], v[36:39], a[24:27]
    s_waitcnt lgkmcnt(4)
    v_add_f32 v8, v8, v20
    v_cvt_pk_bf16_f32 v41, v26, v27
    v_mfma_f32_16x16x32_bf16 a[28:31], a[252:255], v[36:39], a[28:31]
    v_exp_f32 v32, v32
    v_mfma_f32_16x16x32_bf16 v[20:23], a[192:195], v[188:191], v[4:7]
    v_add_f32 v8, v8, v30
    v_add_f32 v8, v8, v31
    v_mfma_f32_16x16x32_bf16 v[20:23], a[196:199], v[192:195], v[20:23]
    v_exp_f32 v33, v33
    v_mfma_f32_16x16x32_bf16 v[20:23], a[200:203], v[196:199], v[20:23]
    v_add_f32 v9, v9, v32
    v_cvt_pk_bf16_f32 v42, v32, v33
    v_mfma_f32_16x16x32_bf16 v[20:23], a[204:207], v[200:203], v[20:23]
    v_exp_f32 v34, v34
    v_mfma_f32_16x16x32_bf16 v[28:31], a[208:211], v[188:191], v[4:7]
    v_add_f32 v9, v9, v24
    v_add_f32 v9, v9, v27
    v_mfma_f32_16x16x32_bf16 v[28:31], a[212:215], v[192:195], v[28:31]
    v_exp_f32 v35, v35
    v_mfma_f32_16x16x32_bf16 v[28:31], a[216:219], v[196:199], v[28:31]
    v_add_f32 v9, v9, v34
    v_cvt_pk_bf16_f32 v43, v34, v35
    v_mfma_f32_16x16x32_bf16 v[28:31], a[220:223], v[200:203], v[28:31]
    v_exp_f32 v20, v20
    v_mfma_f32_16x16x32_bf16 a[32:35], a[224:227], v[40:43], a[32:35]
    v_add_f32 v9, v9, v33
    v_add_f32 v10, v10, v20
    v_mfma_f32_16x16x32_bf16 a[36:39], a[228:231], v[40:43], a[36:39]
    v_exp_f32 v21, v21
    v_mfma_f32_16x16x32_bf16 a[40:43], a[232:235], v[40:43], a[40:43]
    v_add_f32 v9, v9, v26
    v_cvt_pk_bf16_f32 v36, v20, v21
    v_mfma_f32_16x16x32_bf16 a[44:47], a[236:239], v[40:43], a[44:47]
    v_exp_f32 v22, v22
    v_mfma_f32_16x16x32_bf16 a[48:51], a[240:243], v[40:43], a[48:51]
    v_add_f32 v9, v9, v25
    v_add_f32 v9, v9, v35
    v_mfma_f32_16x16x32_bf16 a[52:55], a[244:247], v[40:43], a[52:55]
    v_exp_f32 v23, v23
    v_mfma_f32_16x16x32_bf16 a[56:59], a[248:251], v[40:43], a[56:59]
    v_add_f32 v10, v10, v23
    v_cvt_pk_bf16_f32 v37, v22, v23
    v_mfma_f32_16x16x32_bf16 a[60:63], a[252:255], v[40:43], a[60:63]
    s_waitcnt lgkmcnt(1)
    v_exp_f32 v28, v28
    v_mfma_f32_16x16x32_bf16 v[24:27], a[192:195], v[108:111], v[4:7]
    v_add_f32 v10, v10, v21
    v_add_f32 v10, v10, v22
    v_mfma_f32_16x16x32_bf16 v[24:27], a[196:199], v[112:115], v[24:27]
    s_waitcnt lgkmcnt(0)
    v_exp_f32 v29, v29
    v_mfma_f32_16x16x32_bf16 v[24:27], a[200:203], v[116:119], v[24:27]
    v_add_f32 v10, v10, v28
    v_cvt_pk_bf16_f32 v38, v28, v29
    v_mfma_f32_16x16x32_bf16 v[24:27], a[204:207], v[120:123], v[24:27]
    s_add_u32 m0, s27, 0
    v_exp_f32 v30, v30
    v_mfma_f32_16x16x32_bf16 v[32:35], a[208:211], v[108:111], v[4:7]
    buffer_load_dwordx4 v3, s[12:15], s26 offen nt lds
    v_mfma_f32_16x16x32_bf16 v[32:35], a[212:215], v[112:115], v[32:35]
    v_exp_f32 v31, v31
    v_mfma_f32_16x16x32_bf16 v[32:35], a[216:219], v[116:119], v[32:35]
    ds_read_b128 v[108:111], v2 offset:512
    v_cvt_pk_bf16_f32 v39, v30, v31
    v_mfma_f32_16x16x32_bf16 v[32:35], a[220:223], v[120:123], v[32:35]
    v_exp_f32 v24, v24
    v_mfma_f32_16x16x32_bf16 a[64:67], a[224:227], v[36:39], a[64:67]
    ds_read_b128 v[112:115], v2 offset:576
    ds_read_b128 v[116:119], v2 offset:4736
    v_mfma_f32_16x16x32_bf16 a[68:71], a[228:231], v[36:39], a[68:71]
    v_exp_f32 v25, v25
    v_mfma_f32_16x16x32_bf16 a[72:75], a[232:235], v[36:39], a[72:75]
    ds_read_b128 v[120:123], v2 offset:4800
    v_cvt_pk_bf16_f32 v40, v24, v25
    v_mfma_f32_16x16x32_bf16 a[76:79], a[236:239], v[36:39], a[76:79]
    s_add_u32 m0, s27, 4096
    v_exp_f32 v26, v26
    v_mfma_f32_16x16x32_bf16 a[80:83], a[240:243], v[36:39], a[80:83]
    buffer_load_dwordx4 v3, s[12:15], s26 offen offset:128 nt lds
    v_mfma_f32_16x16x32_bf16 a[84:87], a[244:247], v[36:39], a[84:87]
    v_exp_f32 v27, v27
    v_mfma_f32_16x16x32_bf16 a[88:91], a[248:251], v[36:39], a[88:91]
    v_add_f32 v10, v10, v30
    v_cvt_pk_bf16_f32 v41, v26, v27
    v_mfma_f32_16x16x32_bf16 a[92:95], a[252:255], v[36:39], a[92:95]
    v_exp_f32 v32, v32
    v_mfma_f32_16x16x32_bf16 v[20:23], a[192:195], v[204:207], v[4:7]
    v_add_f32 v10, v10, v29
    v_add_f32 v10, v10, v31
    v_mfma_f32_16x16x32_bf16 v[20:23], a[196:199], v[208:211], v[20:23]
    v_exp_f32 v33, v33
    v_mfma_f32_16x16x32_bf16 v[20:23], a[200:203], v[212:215], v[20:23]
    v_add_f32 v11, v11, v32
    v_cvt_pk_bf16_f32 v42, v32, v33
    v_mfma_f32_16x16x32_bf16 v[20:23], a[204:207], v[216:219], v[20:23]
    v_exp_f32 v34, v34
    v_mfma_f32_16x16x32_bf16 v[28:31], a[208:211], v[204:207], v[4:7]
    v_add_f32 v11, v11, v25
    v_add_f32 v11, v11, v33
    v_mfma_f32_16x16x32_bf16 v[28:31], a[212:215], v[208:211], v[28:31]
    v_exp_f32 v35, v35
    v_mfma_f32_16x16x32_bf16 v[28:31], a[216:219], v[212:215], v[28:31]
    v_add_f32 v11, v11, v26
    v_cvt_pk_bf16_f32 v43, v34, v35
    v_mfma_f32_16x16x32_bf16 v[28:31], a[220:223], v[216:219], v[28:31]
    v_exp_f32 v20, v20
    v_mfma_f32_16x16x32_bf16 a[96:99], a[224:227], v[40:43], a[96:99]
    v_add_f32 v11, v11, v34
    v_add_f32 v11, v11, v35
    v_mfma_f32_16x16x32_bf16 a[100:103], a[228:231], v[40:43], a[100:103]
    v_exp_f32 v21, v21
    v_mfma_f32_16x16x32_bf16 a[104:107], a[232:235], v[40:43], a[104:107]
    v_add_f32 v12, v12, v21
    v_cvt_pk_bf16_f32 v36, v20, v21
    v_mfma_f32_16x16x32_bf16 a[108:111], a[236:239], v[40:43], a[108:111]
    v_exp_f32 v22, v22
    v_mfma_f32_16x16x32_bf16 a[112:115], a[240:243], v[40:43], a[112:115]
    v_add_f32 v11, v11, v24
    v_add_f32 v11, v11, v27
    v_mfma_f32_16x16x32_bf16 a[116:119], a[244:247], v[40:43], a[116:119]
    v_exp_f32 v23, v23
    v_mfma_f32_16x16x32_bf16 a[120:123], a[248:251], v[40:43], a[120:123]
    v_add_f32 v12, v12, v20
    v_cvt_pk_bf16_f32 v37, v22, v23
    v_mfma_f32_16x16x32_bf16 a[124:127], a[252:255], v[40:43], a[124:127]
    s_waitcnt lgkmcnt(3)
    v_exp_f32 v28, v28
    v_mfma_f32_16x16x32_bf16 v[24:27], a[192:195], v[108:111], v[4:7]
    s_waitcnt lgkmcnt(2)
    v_add_f32 v12, v12, v23
    v_add_f32 v12, v12, v28
    v_mfma_f32_16x16x32_bf16 v[24:27], a[196:199], v[112:115], v[24:27]
    s_waitcnt lgkmcnt(1)
    v_exp_f32 v29, v29
    v_mfma_f32_16x16x32_bf16 v[24:27], a[200:203], v[116:119], v[24:27]
    s_waitcnt lgkmcnt(0)
    v_add_f32 v12, v12, v22
    v_cvt_pk_bf16_f32 v38, v28, v29
    v_mfma_f32_16x16x32_bf16 v[24:27], a[204:207], v[120:123], v[24:27]
    s_add_u32 m0, s27, 33792
    v_exp_f32 v30, v30
    v_mfma_f32_16x16x32_bf16 v[32:35], a[208:211], v[108:111], v[4:7]
    buffer_load_dwordx4 v3, s[16:19], s26 offen nt lds
    v_mfma_f32_16x16x32_bf16 v[32:35], a[212:215], v[112:115], v[32:35]
    v_exp_f32 v31, v31
    v_mfma_f32_16x16x32_bf16 v[32:35], a[216:219], v[116:119], v[32:35]
    ds_read_b128 v[108:111], v2 offset:8448
    v_cvt_pk_bf16_f32 v39, v30, v31
    v_mfma_f32_16x16x32_bf16 v[32:35], a[220:223], v[120:123], v[32:35]
    v_exp_f32 v24, v24
    v_mfma_f32_16x16x32_bf16 a[128:131], a[224:227], v[36:39], a[128:131]
    ds_read_b128 v[112:115], v2 offset:8512
    ds_read_b128 v[116:119], v2 offset:12672
    v_mfma_f32_16x16x32_bf16 a[132:135], a[228:231], v[36:39], a[132:135]
    v_exp_f32 v25, v25
    v_mfma_f32_16x16x32_bf16 a[136:139], a[232:235], v[36:39], a[136:139]
    ds_read_b128 v[120:123], v2 offset:12736
    v_cvt_pk_bf16_f32 v40, v24, v25
    v_mfma_f32_16x16x32_bf16 a[140:143], a[236:239], v[36:39], a[140:143]
    s_add_u32 m0, s27, 37888
    v_exp_f32 v26, v26
    v_mfma_f32_16x16x32_bf16 a[144:147], a[240:243], v[36:39], a[144:147]
    buffer_load_dwordx4 v3, s[16:19], s26 offen offset:128 nt lds
    v_mfma_f32_16x16x32_bf16 a[148:151], a[244:247], v[36:39], a[148:151]
    s_add_u32 s26, s26, 8192
    v_exp_f32 v27, v27
    v_mfma_f32_16x16x32_bf16 a[152:155], a[248:251], v[36:39], a[152:155]
    v_add_f32 v12, v12, v30
    v_cvt_pk_bf16_f32 v41, v26, v27
    v_mfma_f32_16x16x32_bf16 a[156:159], a[252:255], v[36:39], a[156:159]
    v_exp_f32 v32, v32
    v_mfma_f32_16x16x32_bf16 v[20:23], a[192:195], v[220:223], v[4:7]
    v_add_f32 v12, v12, v29
    v_add_f32 v12, v12, v31
    v_mfma_f32_16x16x32_bf16 v[20:23], a[196:199], v[224:227], v[20:23]
    v_exp_f32 v33, v33
    v_mfma_f32_16x16x32_bf16 v[20:23], a[200:203], v[228:231], v[20:23]
    v_add_f32 v13, v13, v26
    v_cvt_pk_bf16_f32 v42, v32, v33
    v_mfma_f32_16x16x32_bf16 v[20:23], a[204:207], v[232:235], v[20:23]
    v_exp_f32 v34, v34
    v_mfma_f32_16x16x32_bf16 v[28:31], a[208:211], v[220:223], v[4:7]
    v_add_f32 v13, v13, v25
    v_add_f32 v13, v13, v27
    v_mfma_f32_16x16x32_bf16 v[28:31], a[212:215], v[224:227], v[28:31]
    v_exp_f32 v35, v35
    v_mfma_f32_16x16x32_bf16 v[28:31], a[216:219], v[228:231], v[28:31]
    v_add_f32 v13, v13, v32
    v_cvt_pk_bf16_f32 v43, v34, v35
    v_mfma_f32_16x16x32_bf16 v[28:31], a[220:223], v[232:235], v[28:31]
    v_exp_f32 v20, v20
    v_mfma_f32_16x16x32_bf16 a[160:163], a[224:227], v[40:43], a[160:163]
    v_add_f32 v13, v13, v33
    v_add_f32 v13, v13, v34
    v_mfma_f32_16x16x32_bf16 a[164:167], a[228:231], v[40:43], a[164:167]
    v_exp_f32 v21, v21
    v_mfma_f32_16x16x32_bf16 a[168:171], a[232:235], v[40:43], a[168:171]
    v_add_f32 v13, v13, v24
    v_cvt_pk_bf16_f32 v36, v20, v21
    v_mfma_f32_16x16x32_bf16 a[172:175], a[236:239], v[40:43], a[172:175]
    v_exp_f32 v22, v22
    v_mfma_f32_16x16x32_bf16 a[176:179], a[240:243], v[40:43], a[176:179]
    v_add_f32 v13, v13, v35
    v_add_u32 v1, s29, v1
    v_mfma_f32_16x16x32_bf16 a[180:183], a[244:247], v[40:43], a[180:183]
    v_exp_f32 v23, v23
    v_mfma_f32_16x16x32_bf16 a[184:187], a[248:251], v[40:43], a[184:187]
    v_add_f32 v14, v14, v20
    v_cvt_pk_bf16_f32 v37, v22, v23
    v_mfma_f32_16x16x32_bf16 a[188:191], a[252:255], v[40:43], a[188:191]
    s_waitcnt lgkmcnt(3)
    v_exp_f32 v28, v28
    v_mfma_f32_16x16x32_bf16 v[24:27], a[192:195], v[108:111], v[4:7]
    s_waitcnt lgkmcnt(2)
    v_add_f32 v14, v14, v22
    v_add_f32 v14, v14, v28
    v_mfma_f32_16x16x32_bf16 v[24:27], a[196:199], v[112:115], v[24:27]
    s_waitcnt lgkmcnt(1)
    v_exp_f32 v29, v29
    v_mfma_f32_16x16x32_bf16 v[24:27], a[200:203], v[116:119], v[24:27]
    s_waitcnt lgkmcnt(0)
    v_cvt_pk_bf16_f32 v38, v28, v29
    v_add_u32 v0, s29, v0
    v_mfma_f32_16x16x32_bf16 v[24:27], a[204:207], v[120:123], v[24:27]
    v_exp_f32 v30, v30
    v_mfma_f32_16x16x32_bf16 v[32:35], a[208:211], v[108:111], v[4:7]
    v_add_f32 v14, v14, v29
    v_add_f32 v14, v14, v30
    v_mfma_f32_16x16x32_bf16 v[32:35], a[212:215], v[112:115], v[32:35]
    v_exp_f32 v31, v31
    v_mfma_f32_16x16x32_bf16 v[32:35], a[216:219], v[116:119], v[32:35]
    v_add_f32 v14, v14, v31
    v_cvt_pk_bf16_f32 v39, v30, v31
    v_mfma_f32_16x16x32_bf16 v[32:35], a[220:223], v[120:123], v[32:35]
    v_exp_f32 v24, v24
    v_mfma_f32_16x16x32_bf16 v[44:47], a[224:227], v[36:39], v[44:47]
    v_add_f32 v14, v14, v23
    v_add_f32 v15, v15, v24
    v_mfma_f32_16x16x32_bf16 v[48:51], a[228:231], v[36:39], v[48:51]
    v_exp_f32 v25, v25
    v_mfma_f32_16x16x32_bf16 v[52:55], a[232:235], v[36:39], v[52:55]
    v_add_f32 v15, v15, v25
    v_cvt_pk_bf16_f32 v40, v24, v25
    v_mfma_f32_16x16x32_bf16 v[56:59], a[236:239], v[36:39], v[56:59]
    v_exp_f32 v26, v26
    v_mfma_f32_16x16x32_bf16 v[60:63], a[240:243], v[36:39], v[60:63]
    v_add_f32 v14, v14, v21
    v_add_f32 v15, v15, v26
    v_mfma_f32_16x16x32_bf16 v[64:67], a[244:247], v[36:39], v[64:67]
    s_waitcnt vmcnt(8)
    v_exp_f32 v27, v27
    v_mfma_f32_16x16x32_bf16 v[68:71], a[248:251], v[36:39], v[68:71]
    s_barrier
    v_add_f32 v15, v15, v27
    v_cvt_pk_bf16_f32 v41, v26, v27
    v_mfma_f32_16x16x32_bf16 v[72:75], a[252:255], v[36:39], v[72:75]
    v_exp_f32 v32, v32
    v_mfma_f32_16x16x32_bf16 v[20:23], a[192:195], v[236:239], v[4:7]
    ds_read_b128 a[192:195], v0 offset:0
    v_add_f32 v15, v15, v32
    v_mfma_f32_16x16x32_bf16 v[20:23], a[196:199], v[240:243], v[20:23]
    ds_read_b128 a[196:199], v0 offset:64
    v_exp_f32 v33, v33
    v_mfma_f32_16x16x32_bf16 v[20:23], a[200:203], v[244:247], v[20:23]
    ds_read_b128 a[200:203], v0 offset:4224
    v_cvt_pk_bf16_f32 v42, v32, v33
    v_mfma_f32_16x16x32_bf16 v[20:23], a[204:207], v[248:251], v[20:23]
    v_exp_f32 v34, v34
    v_mfma_f32_16x16x32_bf16 v[28:31], a[208:211], v[236:239], v[4:7]
    ds_read_b128 a[204:207], v0 offset:4288
    ds_read_b128 a[208:211], v0 offset:512
    v_mfma_f32_16x16x32_bf16 v[28:31], a[212:215], v[240:243], v[28:31]
    ds_read_b128 a[212:215], v0 offset:576
    v_exp_f32 v35, v35
    v_mfma_f32_16x16x32_bf16 v[28:31], a[216:219], v[244:247], v[28:31]
    ds_read_b128 a[216:219], v0 offset:4736
    v_cvt_pk_bf16_f32 v43, v34, v35
    v_mfma_f32_16x16x32_bf16 v[28:31], a[220:223], v[248:251], v[28:31]
    v_exp_f32 v20, v20
    v_mfma_f32_16x16x32_bf16 v[76:79], a[224:227], v[40:43], v[76:79]
    ds_read_b128 a[220:223], v0 offset:4800
    v_add_f32 v15, v15, v35
    v_mfma_f32_16x16x32_bf16 v[80:83], a[228:231], v[40:43], v[80:83]
    v_exp_f32 v21, v21
    v_mfma_f32_16x16x32_bf16 v[84:87], a[232:235], v[40:43], v[84:87]
    v_add_f32 v16, v16, v20
    v_cvt_pk_bf16_f32 v36, v20, v21
    v_mfma_f32_16x16x32_bf16 v[88:91], a[236:239], v[40:43], v[88:91]
    v_exp_f32 v22, v22
    v_mfma_f32_16x16x32_bf16 v[92:95], a[240:243], v[40:43], v[92:95]
    v_add_f32 v15, v15, v33
    v_add_f32 v16, v16, v21
    v_mfma_f32_16x16x32_bf16 v[96:99], a[244:247], v[40:43], v[96:99]
    s_sub_u32 s30, s30, 1
    v_exp_f32 v23, v23
    v_mfma_f32_16x16x32_bf16 v[100:103], a[248:251], v[40:43], v[100:103]
    v_add_f32 v15, v15, v34
    v_cvt_pk_bf16_f32 v37, v22, v23
    v_mfma_f32_16x16x32_bf16 v[104:107], a[252:255], v[40:43], v[104:107]
    s_waitcnt lgkmcnt(7)
    v_exp_f32 v28, v28
    s_branch L_loop
L_tail:
    v_mfma_f32_16x16x32_bf16 v[20:23], a[192:195], v[156:159], v[4:7]
    s_waitcnt lgkmcnt(6)
    v_add_f32 v15, v15, v31
    v_add_f32 v16, v16, v27
    v_mfma_f32_16x16x32_bf16 v[20:23], a[196:199], v[160:163], v[20:23]
    s_waitcnt lgkmcnt(5)
    v_exp_f32 v33, v33
    v_mfma_f32_16x16x32_bf16 v[20:23], a[200:203], v[164:167], v[20:23]
    s_waitcnt lgkmcnt(4)
    v_add_f32 v16, v16, v32
    v_cvt_pk_bf16_f32 v42, v32, v33
    v_mfma_f32_16x16x32_bf16 v[20:23], a[204:207], v[168:171], v[20:23]
    s_waitcnt lgkmcnt(3)
    v_exp_f32 v34, v34
    v_mfma_f32_16x16x32_bf16 v[28:31], a[208:211], v[156:159], v[4:7]
    s_waitcnt lgkmcnt(2)
    v_add_f32 v16, v16, v33
    v_add_f32 v16, v16, v34
    v_mfma_f32_16x16x32_bf16 v[28:31], a[212:215], v[160:163], v[28:31]
    s_waitcnt lgkmcnt(1)
    v_exp_f32 v35, v35
    v_mfma_f32_16x16x32_bf16 v[28:31], a[216:219], v[164:167], v[28:31]
    s_waitcnt lgkmcnt(0)
    v_add_f32 v16, v16, v35
    v_cvt_pk_bf16_f32 v43, v34, v35
    v_mfma_f32_16x16x32_bf16 v[28:31], a[220:223], v[168:171], v[28:31]
    v_exp_f32 v20, v20
    v_mfma_f32_16x16x32_bf16 v[124:127], a[224:227], v[40:43], v[124:127]
    ds_read_b64_tr_b16 a[224:225], v1 offset:8448
    ds_read_b64_tr_b16 a[226:227], v1 offset:8960
    v_add_f32 v8, v8, v20
    v_mfma_f32_16x16x32_bf16 v[128:131], a[228:231], v[40:43], v[128:131]
    ds_read_b64_tr_b16 a[228:229], v1 offset:8480
    v_exp_f32 v21, v21
    v_mfma_f32_16x16x32_bf16 v[132:135], a[232:235], v[40:43], v[132:135]
    ds_read_b64_tr_b16 a[230:231], v1 offset:8992
    ds_read_b64_tr_b16 a[232:233], v1 offset:8512
    ds_read_b64_tr_b16 a[234:235], v1 offset:9024
    v_mfma_f32_16x16x32_bf16 v[136:139], a[236:239], v[40:43], v[136:139]
    ds_read_b64_tr_b16 a[236:237], v1 offset:8544
    v_exp_f32 v22, v22
    v_mfma_f32_16x16x32_bf16 v[140:143], a[240:243], v[40:43], v[140:143]
    ds_read_b64_tr_b16 a[238:239], v1 offset:9056
    ds_read_b64_tr_b16 a[240:241], v1 offset:12672
    ds_read_b64_tr_b16 a[242:243], v1 offset:13184
    v_mfma_f32_16x16x32_bf16 v[144:147], a[244:247], v[40:43], v[144:147]
    ds_read_b64_tr_b16 a[246:247], v1 offset:13216
    v_exp_f32 v23, v23
    v_mfma_f32_16x16x32_bf16 v[148:151], a[248:251], v[40:43], v[148:151]
    ds_read_b64_tr_b16 a[244:245], v1 offset:12704
    ds_read_b64_tr_b16 a[248:249], v1 offset:12736
    ds_read_b64_tr_b16 a[250:251], v1 offset:13248
    v_mfma_f32_16x16x32_bf16 v[152:155], a[252:255], v[40:43], v[152:155]
    ds_read_b64_tr_b16 a[254:255], v1 offset:13280
    v_exp_f32 v28, v28
    v_mfma_f32_16x16x32_bf16 v[24:27], a[192:195], v[172:175], v[4:7]
    ds_read_b64_tr_b16 a[252:253], v1 offset:12768
    v_cvt_pk_bf16_f32 v36, v20, v21
    v_cvt_pk_bf16_f32 v37, v22, v23
    v_mfma_f32_16x16x32_bf16 v[24:27], a[196:199], v[176:179], v[24:27]
    v_exp_f32 v29, v29
    v_mfma_f32_16x16x32_bf16 v[24:27], a[200:203], v[180:183], v[24:27]
    v_add_f32 v8, v8, v28
    v_cvt_pk_bf16_f32 v38, v28, v29
    v_mfma_f32_16x16x32_bf16 v[24:27], a[204:207], v[184:187], v[24:27]
    v_exp_f32 v30, v30
    v_mfma_f32_16x16x32_bf16 v[32:35], a[208:211], v[172:175], v[4:7]
    v_add_f32 v8, v8, v22
    v_add_f32 v8, v8, v30
    v_mfma_f32_16x16x32_bf16 v[32:35], a[212:215], v[176:179], v[32:35]
    v_exp_f32 v31, v31
    v_mfma_f32_16x16x32_bf16 v[32:35], a[216:219], v[180:183], v[32:35]
    ds_read_b128 v[108:111], v2 offset:0
    v_cvt_pk_bf16_f32 v39, v30, v31
    v_mfma_f32_16x16x32_bf16 v[32:35], a[220:223], v[184:187], v[32:35]
    s_waitcnt lgkmcnt(15)
    ds_read_b128 v[112:115], v2 offset:64
    v_exp_f32 v24, v24
    v_mfma_f32_16x16x32_bf16 a[0:3], a[224:227], v[36:39], a[0:3]
    s_waitcnt lgkmcnt(14)
    ds_read_b128 v[116:119], v2 offset:4224
    v_add_f32 v8, v8, v21
    v_mfma_f32_16x16x32_bf16 a[4:7], a[228:231], v[36:39], a[4:7]
    s_waitcnt lgkmcnt(13)
    v_exp_f32 v25, v25
    v_mfma_f32_16x16x32_bf16 a[8:11], a[232:235], v[36:39], a[8:11]
    s_waitcnt lgkmcnt(11)
    ds_read_b128 v[120:123], v2 offset:4288
    v_cvt_pk_bf16_f32 v40, v24, v25
    v_mfma_f32_16x16x32_bf16 a[12:15], a[236:239], v[36:39], a[12:15]
    s_waitcnt lgkmcnt(10)
    v_exp_f32 v26, v26
    v_mfma_f32_16x16x32_bf16 a[16:19], a[240:243], v[36:39], a[16:19]
    s_waitcnt lgkmcnt(8)
    v_add_f32 v8, v8, v23
    v_add_f32 v9, v9, v24
    v_mfma_f32_16x16x32_bf16 a[20:23], a[244:247], v[36:39], a[20:23]
    s_waitcnt lgkmcnt(6)
    v_exp_f32 v27, v27
    v_mfma_f32_16x16x32_bf16 a[24:27], a[248:251], v[36:39], a[24:27]
    s_waitcnt lgkmcnt(4)
    v_add_f32 v9, v9, v26
    v_cvt_pk_bf16_f32 v41, v26, v27
    v_mfma_f32_16x16x32_bf16 a[28:31], a[252:255], v[36:39], a[28:31]
    v_exp_f32 v32, v32
    v_mfma_f32_16x16x32_bf16 v[20:23], a[192:195], v[188:191], v[4:7]
    v_add_f32 v8, v8, v29
    v_add_f32 v9, v9, v25
    v_mfma_f32_16x16x32_bf16 v[20:23], a[196:199], v[192:195], v[20:23]
    v_exp_f32 v33, v33
    v_mfma_f32_16x16x32_bf16 v[20:23], a[200:203], v[196:199], v[20:23]
    v_add_f32 v8, v8, v31
    v_cvt_pk_bf16_f32 v42, v32, v33
    v_mfma_f32_16x16x32_bf16 v[20:23], a[204:207], v[200:203], v[20:23]
    v_exp_f32 v34, v34
    v_mfma_f32_16x16x32_bf16 v[28:31], a[208:211], v[188:191], v[4:7]
    v_add_f32 v9, v9, v27
    v_add_f32 v9, v9, v34
    v_mfma_f32_16x16x32_bf16 v[28:31], a[212:215], v[192:195], v[28:31]
    v_exp_f32 v35, v35
    v_mfma_f32_16x16x32_bf16 v[28:31], a[216:219], v[196:199], v[28:31]
    v_add_f32 v9, v9, v32
    v_cvt_pk_bf16_f32 v43, v34, v35
    v_mfma_f32_16x16x32_bf16 v[28:31], a[220:223], v[200:203], v[28:31]
    v_exp_f32 v20, v20
    v_mfma_f32_16x16x32_bf16 a[32:35], a[224:227], v[40:43], a[32:35]
    v_add_f32 v9, v9, v33
    v_add_f32 v10, v10, v20
    v_mfma_f32_16x16x32_bf16 a[36:39], a[228:231], v[40:43], a[36:39]
    v_exp_f32 v21, v21
    v_mfma_f32_16x16x32_bf16 a[40:43], a[232:235], v[40:43], a[40:43]
    v_add_f32 v10, v10, v21
    v_cvt_pk_bf16_f32 v36, v20, v21
    v_mfma_f32_16x16x32_bf16 a[44:47], a[236:239], v[40:43], a[44:47]
    v_exp_f32 v22, v22
    v_mfma_f32_16x16x32_bf16 a[48:51], a[240:243], v[40:43], a[48:51]
    v_add_f32 v9, v9, v35
    v_add_f32 v10, v10, v22
    v_mfma_f32_16x16x32_bf16 a[52:55], a[244:247], v[40:43], a[52:55]
    s_waitcnt vmcnt(4)
    v_exp_f32 v23, v23
    v_mfma_f32_16x16x32_bf16 a[56:59], a[248:251], v[40:43], a[56:59]
    s_barrier
    v_add_f32 v10, v10, v23
    v_cvt_pk_bf16_f32 v37, v22, v23
    v_mfma_f32_16x16x32_bf16 a[60:63], a[252:255], v[40:43], a[60:63]
    s_waitcnt lgkmcnt(3)
    v_exp_f32 v28, v28
    v_mfma_f32_16x16x32_bf16 v[24:27], a[192:195], v[108:111], v[4:7]
    s_waitcnt lgkmcnt(2)
    ds_read_b128 a[192:195], v0 offset:16896
    v_add_f32 v10, v10, v28
    v_mfma_f32_16x16x32_bf16 v[24:27], a[196:199], v[112:115], v[24:27]
    s_waitcnt lgkmcnt(2)
    ds_read_b128 a[196:199], v0 offset:16960
    v_exp_f32 v29, v29
    v_mfma_f32_16x16x32_bf16 v[24:27], a[200:203], v[116:119], v[24:27]
    s_waitcnt lgkmcnt(2)
    ds_read_b128 a[200:203], v0 offset:21120
    v_cvt_pk_bf16_f32 v38, v28, v29
    v_mfma_f32_16x16x32_bf16 v[24:27], a[204:207], v[120:123], v[24:27]
    v_exp_f32 v30, v30
    v_mfma_f32_16x16x32_bf16 v[32:35], a[208:211], v[108:111], v[4:7]
    ds_read_b128 a[204:207], v0 offset:21184
    ds_read_b128 a[208:211], v0 offset:17408
    v_mfma_f32_16x16x32_bf16 v[32:35], a[212:215], v[112:115], v[32:35]
    ds_read_b128 a[212:215], v0 offset:17472
    v_exp_f32 v31, v31
    v_mfma_f32_16x16x32_bf16 v[32:35], a[216:219], v[116:119], v[32:35]
    ds_read_b128 a[216:219], v0 offset:21632
    v_cvt_pk_bf16_f32 v39, v30, v31
    v_mfma_f32_16x16x32_bf16 v[32:35], a[220:223], v[120:123], v[32:35]
    v_exp_f32 v24, v24
    v_mfma_f32_16x16x32_bf16 a[64:67], a[224:227], v[36:39], a[64:67]
    ds_read_b128 a[220:223], v0 offset:21696
    v_add_f32 v10, v10, v31
    v_mfma_f32_16x16x32_bf16 a[68:71], a[228:231], v[36:39], a[68:71]
    v_exp_f32 v25, v25
    v_mfma_f32_16x16x32_bf16 a[72:75], a[232:235], v[36:39], a[72:75]
    v_add_f32 v10, v10, v30
    v_cvt_pk_bf16_f32 v40, v24, v25
    v_mfma_f32_16x16x32_bf16 a[76:79], a[236:239], v[36:39], a[76:79]
    v_exp_f32 v26, v26
    v_mfma_f32_16x16x32_bf16 a[80:83], a[240:243], v[36:39], a[80:83]
    v_add_f32 v10, v10, v29
    v_add_f32 v11, v11, v24
    v_mfma_f32_16x16x32_bf16 a[84:87], a[244:247], v[36:39], a[84:87]
    v_exp_f32 v27, v27
    v_mfma_f32_16x16x32_bf16 a[88:91], a[248:251], v[36:39], a[88:91]
    v_add_f32 v11, v11, v26
    v_cvt_pk_bf16_f32 v41, v26, v27
    v_mfma_f32_16x16x32_bf16 a[92:95], a[252:255], v[36:39], a[92:95]
    s_waitcnt lgkmcnt(7)
    v_exp_f32 v32, v32
    v_mfma_f32_16x16x32_bf16 v[20:23], a[192:195], v[156:159], v[4:7]
    s_waitcnt lgkmcnt(6)
    v_add_f32 v11, v11, v25
    v_add_f32 v11, v11, v27
    v_mfma_f32_16x16x32_bf16 v[20:23], a[196:199], v[160:163], v[20:23]
    s_waitcnt lgkmcnt(5)
    v_exp_f32 v33, v33
    v_mfma_f32_16x16x32_bf16 v[20:23], a[200:203], v[164:167], v[20:23]
    s_waitcnt lgkmcnt(4)
    v_add_f32 v11, v11, v32
    v_cvt_pk_bf16_f32 v42, v32, v33
    v_mfma_f32_16x16x32_bf16 v[20:23], a[204:207], v[168:171], v[20:23]
    s_waitcnt lgkmcnt(3)
    v_exp_f32 v34, v34
    v_mfma_f32_16x16x32_bf16 v[28:31], a[208:211], v[156:159], v[4:7]
    s_waitcnt lgkmcnt(2)
    v_add_f32 v11, v11, v33
    v_add_f32 v11, v11, v34
    v_mfma_f32_16x16x32_bf16 v[28:31], a[212:215], v[160:163], v[28:31]
    s_waitcnt lgkmcnt(1)
    v_exp_f32 v35, v35
    v_mfma_f32_16x16x32_bf16 v[28:31], a[216:219], v[164:167], v[28:31]
    s_waitcnt lgkmcnt(0)
    v_add_f32 v11, v11, v35
    v_cvt_pk_bf16_f32 v43, v34, v35
    v_mfma_f32_16x16x32_bf16 v[28:31], a[220:223], v[168:171], v[28:31]
    v_exp_f32 v20, v20
    v_mfma_f32_16x16x32_bf16 a[96:99], a[224:227], v[40:43], a[96:99]
    ds_read_b64_tr_b16 a[224:225], v1 offset:16896
    ds_read_b64_tr_b16 a[226:227], v1 offset:17408
    v_mfma_f32_16x16x32_bf16 a[100:103], a[228:231], v[40:43], a[100:103]
    ds_read_b64_tr_b16 a[230:231], v1 offset:17440
    v_exp_f32 v21, v21
    v_mfma_f32_16x16x32_bf16 a[104:107], a[232:235], v[40:43], a[104:107]
    ds_read_b64_tr_b16 a[228:229], v1 offset:16928
    ds_read_b64_tr_b16 a[232:233], v1 offset:16960
    ds_read_b64_tr_b16 a[234:235], v1 offset:17472
    v_mfma_f32_16x16x32_bf16 a[108:111], a[236:239], v[40:43], a[108:111]
    ds_read_b64_tr_b16 a[238:239], v1 offset:17504
    v_exp_f32 v22, v22
    v_mfma_f32_16x16x32_bf16 a[112:115], a[240:243], v[40:43], a[112:115]
    ds_read_b64_tr_b16 a[236:237], v1 offset:16992
    ds_read_b64_tr_b16 a[240:241], v1 offset:21120
    ds_read_b64_tr_b16 a[242:243], v1 offset:21632
    v_mfma_f32_16x16x32_bf16 a[116:119], a[244:247], v[40:43], a[116:119]
    ds_read_b64_tr_b16 a[246:247], v1 offset:21664
    v_exp_f32 v23, v23
    v_mfma_f32_16x16x32_bf16 a[120:123], a[248:251], v[40:43], a[120:123]
    ds_read_b64_tr_b16 a[244:245], v1 offset:21152
    ds_read_b64_tr_b16 a[248:249], v1 offset:21184
    ds_read_b64_tr_b16 a[250:251], v1 offset:21696
    v_mfma_f32_16x16x32_bf16 a[124:127], a[252:255], v[40:43], a[124:127]
    v_exp_f32 v28, v28
    v_mfma_f32_16x16x32_bf16 v[24:27], a[192:195], v[172:175], v[4:7]
    ds_read_b64_tr_b16 a[252:253], v1 offset:21216
    ds_read_b64_tr_b16 a[254:255], v1 offset:21728
    v_mfma_f32_16x16x32_bf16 v[24:27], a[196:199], v[176:179], v[24:27]
    v_exp_f32 v29, v29
    v_mfma_f32_16x16x32_bf16 v[24:27], a[200:203], v[180:183], v[24:27]
    v_cvt_pk_bf16_f32 v36, v20, v21
    v_cvt_pk_bf16_f32 v38, v28, v29
    v_mfma_f32_16x16x32_bf16 v[24:27], a[204:207], v[184:187], v[24:27]
    v_exp_f32 v30, v30
    v_mfma_f32_16x16x32_bf16 v[32:35], a[208:211], v[172:175], v[4:7]
    v_add_f32 v8, v8, v28
    v_cvt_pk_bf16_f32 v37, v22, v23
    v_mfma_f32_16x16x32_bf16 v[32:35], a[212:215], v[176:179], v[32:35]
    v_exp_f32 v31, v31
    v_mfma_f32_16x16x32_bf16 v[32:35], a[216:219], v[180:183], v[32:35]
    v_add_f32 v8, v8, v30
    v_cvt_pk_bf16_f32 v39, v30, v31
    v_mfma_f32_16x16x32_bf16 v[32:35], a[220:223], v[184:187], v[32:35]
    s_waitcnt lgkmcnt(14)
    v_exp_f32 v24, v24
    v_mfma_f32_16x16x32_bf16 a[0:3], a[224:227], v[36:39], a[0:3]
    s_waitcnt lgkmcnt(12)
    v_add_f32 v8, v8, v21
    v_add_f32 v8, v8, v29
    v_mfma_f32_16x16x32_bf16 a[4:7], a[228:231], v[36:39], a[4:7]
    s_waitcnt lgkmcnt(10)
    v_exp_f32 v25, v25
    v_mfma_f32_16x16x32_bf16 a[8:11], a[232:235], v[36:39], a[8:11]
    s_waitcnt lgkmcnt(8)
    v_add_f32 v8, v8, v22
    v_cvt_pk_bf16_f32 v40, v24, v25
    v_mfma_f32_16x16x32_bf16 a[12:15], a[236:239], v[36:39], a[12:15]
    s_waitcnt lgkmcnt(6)
    v_exp_f32 v26, v26
    v_mfma_f32_16x16x32_bf16 a[16:19], a[240:243], v[36:39], a[16:19]
    s_waitcnt lgkmcnt(4)
    v_add_f32 v8, v8, v20
    v_add_f32 v8, v8, v23
    v_mfma_f32_16x16x32_bf16 a[20:23], a[244:247], v[36:39], a[20:23]
    s_waitcnt lgkmcnt(2)
    v_exp_f32 v27, v27
    v_mfma_f32_16x16x32_bf16 a[24:27], a[248:251], v[36:39], a[24:27]
    s_waitcnt lgkmcnt(0)
    v_add_f32 v9, v9, v24
    v_cvt_pk_bf16_f32 v41, v26, v27
    v_mfma_f32_16x16x32_bf16 a[28:31], a[252:255], v[36:39], a[28:31]
    v_exp_f32 v32, v32
    v_bfe_u32 v252, v19, 4, 1
    v_bfe_u32 v253, v19, 5, 1
    v_and_b32 v19, 0xffffff00, v19
    v_lshl_add_u32 v19, v252, 5, v19
    v_lshl_add_u32 v19, v253, 4, v19
    v_mfma_f32_16x16x32_bf16 v[20:23], a[192:195], v[188:191], v[4:7]
    v_add_f32 v8, v8, v31
    v_add_f32 v9, v9, v25
    v_mfma_f32_16x16x32_bf16 v[20:23], a[196:199], v[192:195], v[20:23]
    v_exp_f32 v33, v33
    v_mfma_f32_16x16x32_bf16 v[20:23], a[200:203], v[196:199], v[20:23]
    v_add_f32 v9, v9, v26
    v_cvt_pk_bf16_f32 v42, v32, v33
    v_mfma_f32_16x16x32_bf16 v[20:23], a[204:207], v[200:203], v[20:23]
    v_exp_f32 v34, v34
    v_mov_b32 v252, v8
    v_accvgpr_read_b32 v156, a0
    v_accvgpr_read_b32 v157, a1
    v_permlane32_swap_b32 v8, v252
    v_accvgpr_read_b32 v158, a2
    v_add_f32 v8, v8, v252
    v_mov_b32 v252, v8
    v_accvgpr_read_b32 v159, a3
    v_accvgpr_read_b32 v160, a4
    v_permlane16_swap_b32 v8, v252
    v_accvgpr_read_b32 v161, a5
    v_add_f32 v8, v8, v252
    v_rcp_f32 v254, v8
    v_cmp_nle_f32 vcc, s48, v8
    v_cmp_nge_f32 s[46:47], s49, v8
    v_accvgpr_read_b32 v162, a6
    v_accvgpr_read_b32 v163, a7
    s_add_u32 s36, s25, 0
    s_or_b64 s[32:33], s[32:33], vcc
    s_or_b64 s[32:33], s[32:33], s[46:47]
    v_pk_mul_f32 v[156:157], v[156:157], v[254:255] op_sel_hi:[1,0]
    v_pk_mul_f32 v[158:159], v[158:159], v[254:255] op_sel_hi:[1,0]
    v_pk_mul_f32 v[160:161], v[160:161], v[254:255] op_sel_hi:[1,0]
    v_pk_mul_f32 v[162:163], v[162:163], v[254:255] op_sel_hi:[1,0]
    v_cvt_pk_bf16_f32 v172, v156, v157
    v_cvt_pk_bf16_f32 v173, v158, v159
    v_cvt_pk_bf16_f32 v174, v160, v161
    v_cvt_pk_bf16_f32 v175, v162, v163
    v_accvgpr_read_b32 v164, a8
    v_accvgpr_read_b32 v165, a9
    v_accvgpr_read_b32 v166, a10
    v_accvgpr_read_b32 v167, a11
    v_accvgpr_read_b32 v168, a12
    v_accvgpr_read_b32 v169, a13
    v_accvgpr_read_b32 v170, a14
    v_accvgpr_read_b32 v171, a15
    v_permlane16_swap_b32 v172, v174
    v_permlane16_swap_b32 v173, v175
    v_pk_mul_f32 v[164:165], v[164:165], v[254:255] op_sel_hi:[1,0]
    v_pk_mul_f32 v[166:167], v[166:167], v[254:255] op_sel_hi:[1,0]
    v_pk_mul_f32 v[168:169], v[168:169], v[254:255] op_sel_hi:[1,0]
    v_pk_mul_f32 v[170:171], v[170:171], v[254:255] op_sel_hi:[1,0]
    v_cvt_pk_bf16_f32 v176, v164, v165
    v_cvt_pk_bf16_f32 v177, v166, v167
    v_cvt_pk_bf16_f32 v178, v168, v169
    v_cvt_pk_bf16_f32 v179, v170, v171
    buffer_store_dwordx4 v[172:175], v19, s[20:23], s36 offen offset:0 sc1
    v_accvgpr_read_b32 v156, a16
    v_accvgpr_read_b32 v157, a17
    v_accvgpr_read_b32 v158, a18
    v_accvgpr_read_b32 v159, a19
    v_accvgpr_read_b32 v160, a20
    v_accvgpr_read_b32 v161, a21
    v_accvgpr_read_b32 v162, a22
    v_accvgpr_read_b32 v163, a23
    v_permlane16_swap_b32 v176, v178
    v_permlane16_swap_b32 v177, v179
    v_pk_mul_f32 v[156:157], v[156:157], v[254:255] op_sel_hi:[1,0]
    v_pk_mul_f32 v[158:159], v[158:159], v[254:255] op_sel_hi:[1,0]
    v_pk_mul_f32 v[160:161], v[160:161], v[254:255] op_sel_hi:[1,0]
    v_pk_mul_f32 v[162:163], v[162:163], v[254:255] op_sel_hi:[1,0]
    v_cvt_pk_bf16_f32 v180, v156, v157
    v_cvt_pk_bf16_f32 v181, v158, v159
    v_cvt_pk_bf16_f32 v182, v160, v161
    v_cvt_pk_bf16_f32 v183, v162, v163
    buffer_store_dwordx4 v[176:179], v19, s[20:23], s36 offen offset:64 sc1
    v_accvgpr_read_b32 v164, a24
    v_accvgpr_read_b32 v165, a25
    v_accvgpr_read_b32 v166, a26
    v_accvgpr_read_b32 v167, a27
    v_accvgpr_read_b32 v168, a28
    v_accvgpr_read_b32 v169, a29
    v_accvgpr_read_b32 v170, a30
    v_accvgpr_read_b32 v171, a31
    v_permlane16_swap_b32 v180, v182
    v_permlane16_swap_b32 v181, v183
    v_pk_mul_f32 v[164:165], v[164:165], v[254:255] op_sel_hi:[1,0]
    v_pk_mul_f32 v[166:167], v[166:167], v[254:255] op_sel_hi:[1,0]
    v_pk_mul_f32 v[168:169], v[168:169], v[254:255] op_sel_hi:[1,0]
    v_pk_mul_f32 v[170:171], v[170:171], v[254:255] op_sel_hi:[1,0]
    v_cvt_pk_bf16_f32 v184, v164, v165
    v_cvt_pk_bf16_f32 v185, v166, v167
    v_cvt_pk_bf16_f32 v186, v168, v169
    v_cvt_pk_bf16_f32 v187, v170, v171
    buffer_store_dwordx4 v[180:183], v19, s[20:23], s36 offen offset:128 sc1
    s_nop 0
    v_permlane16_swap_b32 v184, v186
    v_permlane16_swap_b32 v185, v187
    s_nop 1
    buffer_store_dwordx4 v[184:187], v19, s[20:23], s36 offen offset:192 sc1
    v_mfma_f32_16x16x32_bf16 v[28:31], a[208:211], v[188:191], v[4:7]
    v_add_f32 v9, v9, v27
    v_add_f32 v9, v9, v33
    v_mfma_f32_16x16x32_bf16 v[28:31], a[212:215], v[192:195], v[28:31]
    v_exp_f32 v35, v35
    v_mfma_f32_16x16x32_bf16 v[28:31], a[216:219], v[196:199], v[28:31]
    v_add_f32 v9, v9, v34
    v_cvt_pk_bf16_f32 v43, v34, v35
    v_mfma_f32_16x16x32_bf16 v[28:31], a[220:223], v[200:203], v[28:31]
    v_exp_f32 v20, v20
    v_mfma_f32_16x16x32_bf16 a[32:35], a[224:227], v[40:43], a[32:35]
    v_add_f32 v9, v9, v32
    v_add_f32 v9, v9, v35
    v_mfma_f32_16x16x32_bf16 a[36:39], a[228:231], v[40:43], a[36:39]
    v_exp_f32 v21, v21
    v_mfma_f32_16x16x32_bf16 a[40:43], a[232:235], v[40:43], a[40:43]
    v_add_f32 v10, v10, v21
    v_cvt_pk_bf16_f32 v36, v20, v21
    v_mfma_f32_16x16x32_bf16 a[44:47], a[236:239], v[40:43], a[44:47]
    v_exp_f32 v22, v22
    v_mfma_f32_16x16x32_bf16 a[48:51], a[240:243], v[40:43], a[48:51]
    v_add_f32 v10, v10, v20
    v_add_f32 v10, v10, v22
    v_mfma_f32_16x16x32_bf16 a[52:55], a[244:247], v[40:43], a[52:55]
    v_exp_f32 v23, v23
    v_mfma_f32_16x16x32_bf16 a[56:59], a[248:251], v[40:43], a[56:59]
    v_add_f32 v10, v10, v23
    v_cvt_pk_bf16_f32 v37, v22, v23
    v_mfma_f32_16x16x32_bf16 a[60:63], a[252:255], v[40:43], a[60:63]
    v_exp_f32 v28, v28
    v_mfma_f32_16x16x32_bf16 v[24:27], a[192:195], v[108:111], v[4:7]
    ds_read_b128 a[192:195], v0 offset:8448
    v_add_f32 v10, v10, v28
    v_mfma_f32_16x16x32_bf16 v[24:27], a[196:199], v[112:115], v[24:27]
    ds_read_b128 a[196:199], v0 offset:8512
    v_exp_f32 v29, v29
    v_mfma_f32_16x16x32_bf16 v[24:27], a[200:203], v[116:119], v[24:27]
    ds_read_b128 a[200:203], v0 offset:12672
    v_cvt_pk_bf16_f32 v38, v28, v29
    v_mfma_f32_16x16x32_bf16 v[24:27], a[204:207], v[120:123], v[24:27]
    ds_read_b128 a[204:207], v0 offset:12736
    v_exp_f32 v30, v30
    v_mov_b32 v252, v9
    v_accvgpr_read_b32 v156, a32
    v_accvgpr_read_b32 v157, a33
    v_permlane32_swap_b32 v9, v252
    v_accvgpr_read_b32 v158, a34
    v_add_f32 v9, v9, v252
    v_mov_b32 v252, v9
    v_accvgpr_read_b32 v159, a35
    v_accvgpr_read_b32 v160, a36
    v_permlane16_swap_b32 v9, v252
    v_accvgpr_read_b32 v161, a37
    v_add_f32 v9, v9, v252
    v_rcp_f32 v254, v9
    v_cmp_nle_f32 vcc, s48, v9
    v_cmp_nge_f32 s[46:47], s49, v9
    v_accvgpr_read_b32 v162, a38
    v_accvgpr_read_b32 v163, a39
    s_add_u32 s36, s25, 4096
    s_or_b64 s[32:33], s[32:33], vcc
    s_or_b64 s[32:33], s[32:33], s[46:47]
    v_pk_mul_f32 v[156:157], v[156:157], v[254:255] op_sel_hi:[1,0]
    v_pk_mul_f32 v[158:159], v[158:159], v[254:255] op_sel_hi:[1,0]
    v_pk_mul_f32 v[160:161], v[160:161], v[254:255] op_sel_hi:[1,0]
    v_pk_mul_f32 v[162:163], v[162:163], v[254:255] op_sel_hi:[1,0]
    v_cvt_pk_bf16_f32 v172, v156, v157
    v_cvt_pk_bf16_f32 v173, v158, v159
    v_cvt_pk_bf16_f32 v174, v160, v161
    v_cvt_pk_bf16_f32 v175, v162, v163
    v_accvgpr_read_b32 v164, a40
    v_accvgpr_read_b32 v165, a41
    v_accvgpr_read_b32 v166, a42
    v_accvgpr_read_b32 v167, a43
    v_accvgpr_read_b32 v168, a44
    v_accvgpr_read_b32 v169, a45
    v_accvgpr_read_b32 v170, a46
    v_accvgpr_read_b32 v171, a47
    v_permlane16_swap_b32 v172, v174
    v_permlane16_swap_b32 v173, v175
    v_pk_mul_f32 v[164:165], v[164:165], v[254:255] op_sel_hi:[1,0]
    v_pk_mul_f32 v[166:167], v[166:167], v[254:255] op_sel_hi:[1,0]
    v_pk_mul_f32 v[168:169], v[168:169], v[254:255] op_sel_hi:[1,0]
    v_pk_mul_f32 v[170:171], v[170:171], v[254:255] op_sel_hi:[1,0]
    v_cvt_pk_bf16_f32 v176, v164, v165
    v_cvt_pk_bf16_f32 v177, v166, v167
    v_cvt_pk_bf16_f32 v178, v168, v169
    v_cvt_pk_bf16_f32 v179, v170, v171
    buffer_store_dwordx4 v[172:175], v19, s[20:23], s36 offen offset:0 sc1
    v_accvgpr_read_b32 v156, a48
    v_accvgpr_read_b32 v157, a49
    v_accvgpr_read_b32 v158, a50
    v_accvgpr_read_b32 v159, a51
    v_accvgpr_read_b32 v160, a52
    v_accvgpr_read_b32 v161, a53
    v_accvgpr_read_b32 v162, a54
    v_accvgpr_read_b32 v163, a55
    v_permlane16_swap_b32 v176, v178
    v_permlane16_swap_b32 v177, v179
    v_pk_mul_f32 v[156:157], v[156:157], v[254:255] op_sel_hi:[1,0]
    v_pk_mul_f32 v[158:159], v[158:159], v[254:255] op_sel_hi:[1,0]
    v_pk_mul_f32 v[160:161], v[160:161], v[254:255] op_sel_hi:[1,0]
    v_pk_mul_f32 v[162:163], v[162:163], v[254:255] op_sel_hi:[1,0]
    v_cvt_pk_bf16_f32 v180, v156, v157
    v_cvt_pk_bf16_f32 v181, v158, v159
    v_cvt_pk_bf16_f32 v182, v160, v161
    v_cvt_pk_bf16_f32 v183, v162, v163
    buffer_store_dwordx4 v[176:179], v19, s[20:23], s36 offen offset:64 sc1
    v_accvgpr_read_b32 v164, a56
    v_accvgpr_read_b32 v165, a57
    v_accvgpr_read_b32 v166, a58
    v_accvgpr_read_b32 v167, a59
    v_accvgpr_read_b32 v168, a60
    v_accvgpr_read_b32 v169, a61
    v_accvgpr_read_b32 v170, a62
    v_accvgpr_read_b32 v171, a63
    v_permlane16_swap_b32 v180, v182
    v_permlane16_swap_b32 v181, v183
    v_pk_mul_f32 v[164:165], v[164:165], v[254:255] op_sel_hi:[1,0]
    v_pk_mul_f32 v[166:167], v[166:167], v[254:255] op_sel_hi:[1,0]
    v_pk_mul_f32 v[168:169], v[168:169], v[254:255] op_sel_hi:[1,0]
    v_pk_mul_f32 v[170:171], v[170:171], v[254:255] op_sel_hi:[1,0]
    v_cvt_pk_bf16_f32 v184, v164, v165
    v_cvt_pk_bf16_f32 v185, v166, v167
    v_cvt_pk_bf16_f32 v186, v168, v169
    v_cvt_pk_bf16_f32 v187, v170, v171
    buffer_store_dwordx4 v[180:183], v19, s[20:23], s36 offen offset:128 sc1
    s_nop 0
    v_permlane16_swap_b32 v184, v186
    v_permlane16_swap_b32 v185, v187
    s_nop 1
    buffer_store_dwordx4 v[184:187], v19, s[20:23], s36 offen offset:192 sc1
    v_mfma_f32_16x16x32_bf16 v[32:35], a[208:211], v[108:111], v[4:7]
    ds_read_b128 a[208:211], v0 offset:8960
    v_add_f32 v10, v10, v29
    v_mfma_f32_16x16x32_bf16 v[32:35], a[212:215], v[112:115], v[32:35]
    ds_read_b128 a[212:215], v0 offset:9024
    v_exp_f32 v31, v31
    v_mfma_f32_16x16x32_bf16 v[32:35], a[216:219], v[116:119], v[32:35]
    ds_read_b128 a[216:219], v0 offset:13184
    ds_read_b128 v[108:111], v2 offset:512
    v_cvt_pk_bf16_f32 v39, v30, v31
    v_mfma_f32_16x16x32_bf16 v[32:35], a[220:223], v[120:123], v[32:35]
    ds_read_b128 v[112:115], v2 offset:576
    v_exp_f32 v24, v24
    v_mfma_f32_16x16x32_bf16 a[64:67], a[224:227], v[36:39], a[64:67]
    ds_read_b128 a[220:223], v0 offset:13248
    ds_read_b128 v[116:119], v2 offset:4736
    v_mfma_f32_16x16x32_bf16 a[68:71], a[228:231], v[36:39], a[68:71]
    ds_read_b128 v[120:123], v2 offset:4800
    v_exp_f32 v25, v25
    v_mfma_f32_16x16x32_bf16 a[72:75], a[232:235], v[36:39], a[72:75]
    v_add_f32 v11, v11, v24
    v_cvt_pk_bf16_f32 v40, v24, v25
    v_mfma_f32_16x16x32_bf16 a[76:79], a[236:239], v[36:39], a[76:79]
    v_exp_f32 v26, v26
    v_mfma_f32_16x16x32_bf16 a[80:83], a[240:243], v[36:39], a[80:83]
    v_add_f32 v10, v10, v31
    v_add_f32 v11, v11, v26
    v_mfma_f32_16x16x32_bf16 a[84:87], a[244:247], v[36:39], a[84:87]
    v_exp_f32 v27, v27
    v_mfma_f32_16x16x32_bf16 a[88:91], a[248:251], v[36:39], a[88:91]
    v_add_f32 v10, v10, v30
    v_cvt_pk_bf16_f32 v41, v26, v27
    v_mfma_f32_16x16x32_bf16 a[92:95], a[252:255], v[36:39], a[92:95]
    s_waitcnt lgkmcnt(11)
    v_exp_f32 v32, v32
    v_mfma_f32_16x16x32_bf16 v[20:23], a[192:195], v[204:207], v[4:7]
    s_waitcnt lgkmcnt(10)
    v_add_f32 v11, v11, v25
    v_add_f32 v11, v11, v27
    v_mfma_f32_16x16x32_bf16 v[20:23], a[196:199], v[208:211], v[20:23]
    s_waitcnt lgkmcnt(9)
    v_exp_f32 v33, v33
    v_mfma_f32_16x16x32_bf16 v[20:23], a[200:203], v[212:215], v[20:23]
    s_waitcnt lgkmcnt(8)
    v_add_f32 v11, v11, v32
    v_cvt_pk_bf16_f32 v42, v32, v33
    v_mfma_f32_16x16x32_bf16 v[20:23], a[204:207], v[216:219], v[20:23]
    v_exp_f32 v34, v34
    v_mov_b32 v252, v10
    v_accvgpr_read_b32 v156, a64
    v_accvgpr_read_b32 v157, a65
    v_permlane32_swap_b32 v10, v252
    v_accvgpr_read_b32 v158, a66
    v_add_f32 v10, v10, v252
    v_mov_b32 v252, v10
    v_accvgpr_read_b32 v159, a67
    v_accvgpr_read_b32 v160, a68
    v_permlane16_swap_b32 v10, v252
    v_accvgpr_read_b32 v161, a69
    v_add_f32 v10, v10, v252
    v_rcp_f32 v254, v10
    v_cmp_nle_f32 vcc, s48, v10
    v_cmp_nge_f32 s[46:47], s49, v10
    v_accvgpr_read_b32 v162, a70
    v_accvgpr_read_b32 v163, a71
    s_add_u32 s36, s25, 8192
    s_or_b64 s[32:33], s[32:33], vcc
    s_or_b64 s[32:33], s[32:33], s[46:47]
    v_pk_mul_f32 v[156:157], v[156:157], v[254:255] op_sel_hi:[1,0]
    v_pk_mul_f32 v[158:159], v[158:159], v[254:255] op_sel_hi:[1,0]
    v_pk_mul_f32 v[160:161], v[160:161], v[254:255] op_sel_hi:[1,0]
    v_pk_mul_f32 v[162:163], v[162:163], v[254:255] op_sel_hi:[1,0]
    v_cvt_pk_bf16_f32 v172, v156, v157
    v_cvt_pk_bf16_f32 v173, v158, v159
    v_cvt_pk_bf16_f32 v174, v160, v161
    v_cvt_pk_bf16_f32 v175, v162, v163
    v_accvgpr_read_b32 v164, a72
    v_accvgpr_read_b32 v165, a73
    v_accvgpr_read_b32 v166, a74
    v_accvgpr_read_b32 v167, a75
    v_accvgpr_read_b32 v168, a76
    v_accvgpr_read_b32 v169, a77
    v_accvgpr_read_b32 v170, a78
    v_accvgpr_read_b32 v171, a79
    v_permlane16_swap_b32 v172, v174
    v_permlane16_swap_b32 v173, v175
    v_pk_mul_f32 v[164:165], v[164:165], v[254:255] op_sel_hi:[1,0]
    v_pk_mul_f32 v[166:167], v[166:167], v[254:255] op_sel_hi:[1,0]
    v_pk_mul_f32 v[168:169], v[168:169], v[254:255] op_sel_hi:[1,0]
    v_pk_mul_f32 v[170:171], v[170:171], v[254:255] op_sel_hi:[1,0]
    v_cvt_pk_bf16_f32 v176, v164, v165
    v_cvt_pk_bf16_f32 v177, v166, v167
    v_cvt_pk_bf16_f32 v178, v168, v169
    v_cvt_pk_bf16_f32 v179, v170, v171
    buffer_store_dwordx4 v[172:175], v19, s[20:23], s36 offen offset:0 sc1
    v_accvgpr_read_b32 v156, a80
    v_accvgpr_read_b32 v157, a81
    v_accvgpr_read_b32 v158, a82
    v_accvgpr_read_b32 v159, a83
    v_accvgpr_read_b32 v160, a84
    v_accvgpr_read_b32 v161, a85
    v_accvgpr_read_b32 v162, a86
    v_accvgpr_read_b32 v163, a87
    v_permlane16_swap_b32 v176, v178
    v_permlane16_swap_b32 v177, v179
    v_pk_mul_f32 v[156:157], v[156:157], v[254:255] op_sel_hi:[1,0]
    v_pk_mul_f32 v[158:159], v[158:159], v[254:255] op_sel_hi:[1,0]
    v_pk_mul_f32 v[160:161], v[160:161], v[254:255] op_sel_hi:[1,0]
    v_pk_mul_f32 v[162:163], v[162:163], v[254:255] op_sel_hi:[1,0]
    v_cvt_pk_bf16_f32 v180, v156, v157
    v_cvt_pk_bf16_f32 v181, v158, v159
    v_cvt_pk_bf16_f32 v182, v160, v161
    v_cvt_pk_bf16_f32 v183, v162, v163
    buffer_store_dwordx4 v[176:179], v19, s[20:23], s36 offen offset:64 sc1
    v_accvgpr_read_b32 v164, a88
    v_accvgpr_read_b32 v165, a89
    v_accvgpr_read_b32 v166, a90
    v_accvgpr_read_b32 v167, a91
    v_accvgpr_read_b32 v168, a92
    v_accvgpr_read_b32 v169, a93
    v_accvgpr_read_b32 v170, a94
    v_accvgpr_read_b32 v171, a95
    v_permlane16_swap_b32 v180, v182
    v_permlane16_swap_b32 v181, v183
    v_pk_mul_f32 v[164:165], v[164:165], v[254:255] op_sel_hi:[1,0]
    v_pk_mul_f32 v[166:167], v[166:167], v[254:255] op_sel_hi:[1,0]
    v_pk_mul_f32 v[168:169], v[168:169], v[254:255] op_sel_hi:[1,0]
    v_pk_mul_f32 v[170:171], v[170:171], v[254:255] op_sel_hi:[1,0]
    v_cvt_pk_bf16_f32 v184, v164, v165
    v_cvt_pk_bf16_f32 v185, v166, v167
    v_cvt_pk_bf16_f32 v186, v168, v169
    v_cvt_pk_bf16_f32 v187, v170, v171
    buffer_store_dwordx4 v[180:183], v19, s[20:23], s36 offen offset:128 sc1
    s_nop 0
    v_permlane16_swap_b32 v184, v186
    v_permlane16_swap_b32 v185, v187
    s_nop 1
    buffer_store_dwordx4 v[184:187], v19, s[20:23], s36 offen offset:192 sc1
    s_waitcnt lgkmcnt(7)
    v_mfma_f32_16x16x32_bf16 v[28:31], a[208:211], v[204:207], v[4:7]
    s_waitcnt lgkmcnt(6)
    v_add_f32 v11, v11, v33
    v_add_f32 v11, v11, v34
    v_mfma_f32_16x16x32_bf16 v[28:31], a[212:215], v[208:211], v[28:31]
    s_waitcnt lgkmcnt(5)
    v_exp_f32 v35, v35
    v_mfma_f32_16x16x32_bf16 v[28:31], a[216:219], v[212:215], v[28:31]
    s_waitcnt lgkmcnt(2)
    v_add_f32 v11, v11, v35
    v_cvt_pk_bf16_f32 v43, v34, v35
    v_mfma_f32_16x16x32_bf16 v[28:31], a[220:223], v[216:219], v[28:31]
    v_exp_f32 v20, v20
    v_mfma_f32_16x16x32_bf16 a[96:99], a[224:227], v[40:43], a[96:99]
    ds_read_b64_tr_b16 a[224:225], v1 offset:8448
    ds_read_b64_tr_b16 a[226:227], v1 offset:8960
    v_mfma_f32_16x16x32_bf16 a[100:103], a[228:231], v[40:43], a[100:103]
    ds_read_b64_tr_b16 a[230:231], v1 offset:8992
    v_exp_f32 v21, v21
    v_mfma_f32_16x16x32_bf16 a[104:107], a[232:235], v[40:43], a[104:107]
    ds_read_b64_tr_b16 a[228:229], v1 offset:8480
    ds_read_b64_tr_b16 a[232:233], v1 offset:8512
    ds_read_b64_tr_b16 a[234:235], v1 offset:9024
    v_mfma_f32_16x16x32_bf16 a[108:111], a[236:239], v[40:43], a[108:111]
    ds_read_b64_tr_b16 a[236:237], v1 offset:8544
    v_exp_f32 v22, v22
    v_mfma_f32_16x16x32_bf16 a[112:115], a[240:243], v[40:43], a[112:115]
    ds_read_b64_tr_b16 a[238:239], v1 offset:9056
    ds_read_b64_tr_b16 a[240:241], v1 offset:12672
    ds_read_b64_tr_b16 a[242:243], v1 offset:13184
    v_mfma_f32_16x16x32_bf16 a[116:119], a[244:247], v[40:43], a[116:119]
    ds_read_b64_tr_b16 a[244:245], v1 offset:12704
    v_exp_f32 v23, v23
    v_mfma_f32_16x16x32_bf16 a[120:123], a[248:251], v[40:43], a[120:123]
    ds_read_b64_tr_b16 a[246:247], v1 offset:13216
    ds_read_b64_tr_b16 a[248:249], v1 offset:12736
    ds_read_b64_tr_b16 a[250:251], v1 offset:13248
    v_mfma_f32_16x16x32_bf16 a[124:127], a[252:255], v[40:43], a[124:127]
    v_exp_f32 v28, v28
    v_mfma_f32_16x16x32_bf16 v[24:27], a[192:195], v[108:111], v[4:7]
    ds_read_b64_tr_b16 a[252:253], v1 offset:12768
    ds_read_b64_tr_b16 a[254:255], v1 offset:13280
    v_mfma_f32_16x16x32_bf16 v[24:27], a[196:199], v[112:115], v[24:27]
    s_waitcnt lgkmcnt(15)
    v_exp_f32 v29, v29
    v_mfma_f32_16x16x32_bf16 v[24:27], a[200:203], v[116:119], v[24:27]
    v_cvt_pk_bf16_f32 v36, v20, v21
    v_cvt_pk_bf16_f32 v38, v28, v29
    v_mfma_f32_16x16x32_bf16 v[24:27], a[204:207], v[120:123], v[24:27]
    v_exp_f32 v30, v30
    v_mov_b32 v252, v11
    v_accvgpr_read_b32 v156, a96
    v_accvgpr_read_b32 v157, a97
    v_permlane32_swap_b32 v11, v252
    v_accvgpr_read_b32 v158, a98
    v_add_f32 v11, v11, v252
    v_mov_b32 v252, v11
    v_accvgpr_read_b32 v159, a99
    v_accvgpr_read_b32 v160, a100
    v_permlane16_swap_b32 v11, v252
    v_accvgpr_read_b32 v161, a101
    v_add_f32 v11, v11, v252
    v_rcp_f32 v254, v11
    v_cmp_nle_f32 vcc, s48, v11
    v_cmp_nge_f32 s[46:47], s49, v11
    v_accvgpr_read_b32 v162, a102
    v_accvgpr_read_b32 v163, a103
    s_add_u32 s36, s25, 12288
    s_or_b64 s[32:33], s[32:33], vcc
    s_or_b64 s[32:33], s[32:33], s[46:47]
    v_pk_mul_f32 v[156:157], v[156:157], v[254:255] op_sel_hi:[1,0]
    v_pk_mul_f32 v[158:159], v[158:159], v[254:255] op_sel_hi:[1,0]
    v_pk_mul_f32 v[160:161], v[160:161], v[254:255] op_sel_hi:[1,0]
    v_pk_mul_f32 v[162:163], v[162:163], v[254:255] op_sel_hi:[1,0]
    v_cvt_pk_bf16_f32 v172, v156, v157
    v_cvt_pk_bf16_f32 v173, v158, v159
    v_cvt_pk_bf16_f32 v174, v160, v161
    v_cvt_pk_bf16_f32 v175, v162, v163
    v_accvgpr_read_b32 v164, a104
    v_accvgpr_read_b32 v165, a105
    v_accvgpr_read_b32 v166, a106
    v_accvgpr_read_b32 v167, a107
    v_accvgpr_read_b32 v168, a108
    v_accvgpr_read_b32 v169, a109
    v_accvgpr_read_b32 v170, a110
    v_accvgpr_read_b32 v171, a111
    v_permlane16_swap_b32 v172, v174
    v_permlane16_swap_b32 v173, v175
    v_pk_mul_f32 v[164:165], v[164:165], v[254:255] op_sel_hi:[1,0]
    v_pk_mul_f32 v[166:167], v[166:167], v[254:255] op_sel_hi:[1,0]
    v_pk_mul_f32 v[168:169], v[168:169], v[254:255] op_sel_hi:[1,0]
    v_pk_mul_f32 v[170:171], v[170:171], v[254:255] op_sel_hi:[1,0]
    v_cvt_pk_bf16_f32 v176, v164, v165
    v_cvt_pk_bf16_f32 v177, v166, v167
    v_cvt_pk_bf16_f32 v178, v168, v169
    v_cvt_pk_bf16_f32 v179, v170, v171
    buffer_store_dwordx4 v[172:175], v19, s[20:23], s36 offen offset:0 sc1
    v_accvgpr_read_b32 v156, a112
    v_accvgpr_read_b32 v157, a113
    v_accvgpr_read_b32 v158, a114
    v_accvgpr_read_b32 v159, a115
    v_accvgpr_read_b32 v160, a116
    v_accvgpr_read_b32 v161, a117
    v_accvgpr_read_b32 v162, a118
    v_accvgpr_read_b32 v163, a119
    v_permlane16_swap_b32 v176, v178
    v_permlane16_swap_b32 v177, v179
    v_pk_mul_f32 v[156:157], v[156:157], v[254:255] op_sel_hi:[1,0]
    v_pk_mul_f32 v[158:159], v[158:159], v[254:255] op_sel_hi:[1,0]
    v_pk_mul_f32 v[160:161], v[160:161], v[254:255] op_sel_hi:[1,0]
    v_pk_mul_f32 v[162:163], v[162:163], v[254:255] op_sel_hi:[1,0]
    v_cvt_pk_bf16_f32 v180, v156, v157
    v_cvt_pk_bf16_f32 v181, v158, v159
    v_cvt_pk_bf16_f32 v182, v160, v161
    v_cvt_pk_bf16_f32 v183, v162, v163
    buffer_store_dwordx4 v[176:179], v19, s[20:23], s36 offen offset:64 sc1
    v_accvgpr_read_b32 v164, a120
    v_accvgpr_read_b32 v165, a121
    v_accvgpr_read_b32 v166, a122
    v_accvgpr_read_b32 v167, a123
    v_accvgpr_read_b32 v168, a124
    v_accvgpr_read_b32 v169, a125
    v_accvgpr_read_b32 v170, a126
    v_accvgpr_read_b32 v171, a127
    v_permlane16_swap_b32 v180, v182
    v_permlane16_swap_b32 v181, v183
    v_pk_mul_f32 v[164:165], v[164:165], v[254:255] op_sel_hi:[1,0]
    v_pk_mul_f32 v[166:167], v[166:167], v[254:255] op_sel_hi:[1,0]
    v_pk_mul_f32 v[168:169], v[168:169], v[254:255] op_sel_hi:[1,0]
    v_pk_mul_f32 v[170:171], v[170:171], v[254:255] op_sel_hi:[1,0]
    v_cvt_pk_bf16_f32 v184, v164, v165
    v_cvt_pk_bf16_f32 v185, v166, v167
    v_cvt_pk_bf16_f32 v186, v168, v169
    v_cvt_pk_bf16_f32 v187, v170, v171
    buffer_store_dwordx4 v[180:183], v19, s[20:23], s36 offen offset:128 sc1
    s_nop 0
    v_permlane16_swap_b32 v184, v186
    v_permlane16_swap_b32 v185, v187
    s_nop 1
    buffer_store_dwordx4 v[184:187], v19, s[20:23], s36 offen offset:192 sc1
    v_mfma_f32_16x16x32_bf16 v[32:35], a[208:211], v[108:111], v[4:7]
    v_add_f32 v12, v12, v21
    v_cvt_pk_bf16_f32 v37, v22, v23
    v_mfma_f32_16x16x32_bf16 v[32:35], a[212:215], v[112:115], v[32:35]
    v_exp_f32 v31, v31
    v_mfma_f32_16x16x32_bf16 v[32:35], a[216:219], v[116:119], v[32:35]
    ds_read_b128 v[108:111], v2 offset:8448
    v_cvt_pk_bf16_f32 v39, v30, v31
    v_mfma_f32_16x16x32_bf16 v[32:35], a[220:223], v[120:123], v[32:35]
    s_waitcnt lgkmcnt(15)
    v_exp_f32 v24, v24
    v_mfma_f32_16x16x32_bf16 a[128:131], a[224:227], v[36:39], a[128:131]
    s_waitcnt lgkmcnt(13)
    ds_read_b128 v[112:115], v2 offset:8512
    ds_read_b128 v[116:119], v2 offset:12672
    v_mfma_f32_16x16x32_bf16 a[132:135], a[228:231], v[36:39], a[132:135]
    s_waitcnt lgkmcnt(13)
    v_exp_f32 v25, v25
    v_mfma_f32_16x16x32_bf16 a[136:139], a[232:235], v[36:39], a[136:139]
    s_waitcnt lgkmcnt(11)
    ds_read_b128 v[120:123], v2 offset:12736
    v_cvt_pk_bf16_f32 v40, v24, v25
    v_mfma_f32_16x16x32_bf16 a[140:143], a[236:239], v[36:39], a[140:143]
    s_waitcnt lgkmcnt(10)
    v_exp_f32 v26, v26
    v_mfma_f32_16x16x32_bf16 a[144:147], a[240:243], v[36:39], a[144:147]
    s_waitcnt lgkmcnt(8)
    v_add_f32 v12, v12, v20
    v_add_f32 v12, v12, v23
    v_mfma_f32_16x16x32_bf16 a[148:151], a[244:247], v[36:39], a[148:151]
    s_waitcnt lgkmcnt(6)
    v_exp_f32 v27, v27
    v_mfma_f32_16x16x32_bf16 a[152:155], a[248:251], v[36:39], a[152:155]
    s_waitcnt lgkmcnt(4)
    v_add_f32 v12, v12, v22
    v_cvt_pk_bf16_f32 v41, v26, v27
    v_mfma_f32_16x16x32_bf16 a[156:159], a[252:255], v[36:39], a[156:159]
    v_exp_f32 v32, v32
    v_mfma_f32_16x16x32_bf16 v[20:23], a[192:195], v[220:223], v[4:7]
    v_add_f32 v12, v12, v28
    v_add_f32 v12, v12, v31
    v_mfma_f32_16x16x32_bf16 v[20:23], a[196:199], v[224:227], v[20:23]
    v_exp_f32 v33, v33
    v_mfma_f32_16x16x32_bf16 v[20:23], a[200:203], v[228:231], v[20:23]
    v_add_f32 v12, v12, v29
    v_add_f32 v12, v12, v30
    v_mfma_f32_16x16x32_bf16 v[20:23], a[204:207], v[232:235], v[20:23]
    v_exp_f32 v34, v34
    v_mfma_f32_16x16x32_bf16 v[28:31], a[208:211], v[220:223], v[4:7]
    v_add_f32 v13, v13, v34
    v_cvt_pk_bf16_f32 v42, v32, v33
    v_mfma_f32_16x16x32_bf16 v[28:31], a[212:215], v[224:227], v[28:31]
    v_exp_f32 v35, v35
    v_mfma_f32_16x16x32_bf16 v[28:31], a[216:219], v[228:231], v[28:31]
    v_add_f32 v13, v13, v25
    v_cvt_pk_bf16_f32 v43, v34, v35
    v_mfma_f32_16x16x32_bf16 v[28:31], a[220:223], v[232:235], v[28:31]
    v_exp_f32 v20, v20
    v_mfma_f32_16x16x32_bf16 a[160:163], a[224:227], v[40:43], a[160:163]
    v_add_f32 v13, v13, v26
    v_add_f32 v14, v14, v20
    v_mfma_f32_16x16x32_bf16 a[164:167], a[228:231], v[40:43], a[164:167]
    v_exp_f32 v21, v21
    v_mfma_f32_16x16x32_bf16 a[168:171], a[232:235], v[40:43], a[168:171]
    v_add_f32 v14, v14, v21
    v_cvt_pk_bf16_f32 v36, v20, v21
    v_mfma_f32_16x16x32_bf16 a[172:175], a[236:239], v[40:43], a[172:175]
    v_exp_f32 v22, v22
    v_mfma_f32_16x16x32_bf16 a[176:179], a[240:243], v[40:43], a[176:179]
    v_add_f32 v13, v13, v27
    v_add_f32 v13, v13, v32
    v_mfma_f32_16x16x32_bf16 a[180:183], a[244:247], v[40:43], a[180:183]
    v_exp_f32 v23, v23
    v_mfma_f32_16x16x32_bf16 a[184:187], a[248:251], v[40:43], a[184:187]
    v_add_f32 v13, v13, v24
    v_cvt_pk_bf16_f32 v37, v22, v23
    v_mfma_f32_16x16x32_bf16 a[188:191], a[252:255], v[40:43], a[188:191]
    s_waitcnt lgkmcnt(3)
    v_exp_f32 v28, v28
    v_mfma_f32_16x16x32_bf16 v[24:27], a[192:195], v[108:111], v[4:7]
    s_waitcnt lgkmcnt(2)
    v_add_f32 v13, v13, v35
    v_add_f32 v14, v14, v28
    v_mfma_f32_16x16x32_bf16 v[24:27], a[196:199], v[112:115], v[24:27]
    s_waitcnt lgkmcnt(1)
    v_exp_f32 v29, v29
    v_mfma_f32_16x16x32_bf16 v[24:27], a[200:203], v[116:119], v[24:27]
    s_waitcnt lgkmcnt(0)
    v_add_f32 v13, v13, v33
    v_cvt_pk_bf16_f32 v38, v28, v29
    v_mfma_f32_16x16x32_bf16 v[24:27], a[204:207], v[120:123], v[24:27]
    v_exp_f32 v30, v30
    v_mfma_f32_16x16x32_bf16 v[32:35], a[208:211], v[108:111], v[4:7]
    v_add_f32 v14, v14, v29
    v_add_f32 v14, v14, v30
    v_mfma_f32_16x16x32_bf16 v[32:35], a[212:215], v[112:115], v[32:35]
    v_exp_f32 v31, v31
    v_mfma_f32_16x16x32_bf16 v[32:35], a[216:219], v[116:119], v[32:35]
    v_add_f32 v14, v14, v31
    v_cvt_pk_bf16_f32 v39, v30, v31
    v_mfma_f32_16x16x32_bf16 v[32:35], a[220:223], v[120:123], v[32:35]
    v_exp_f32 v24, v24
    v_mfma_f32_16x16x32_bf16 v[44:47], a[224:227], v[36:39], v[44:47]
    v_add_f32 v14, v14, v23
    v_add_f32 v15, v15, v24
    v_mfma_f32_16x16x32_bf16 v[48:51], a[228:231], v[36:39], v[48:51]
    v_exp_f32 v25, v25
    v_mfma_f32_16x16x32_bf16 v[52:55], a[232:235], v[36:39], v[52:55]
    v_add_f32 v15, v15, v25
    v_cvt_pk_bf16_f32 v40, v24, v25
    v_mfma_f32_16x16x32_bf16 v[56:59], a[236:239], v[36:39], v[56:59]
    v_exp_f32 v26, v26
    v_mfma_f32_16x16x32_bf16 v[60:63], a[240:243], v[36:39], v[60:63]
    v_add_f32 v14, v14, v22
    v_add_f32 v15, v15, v26
    v_mfma_f32_16x16x32_bf16 v[64:67], a[244:247], v[36:39], v[64:67]
    v_exp_f32 v27, v27
    v_mfma_f32_16x16x32_bf16 v[68:71], a[248:251], v[36:39], v[68:71]
    v_add_f32 v15, v15, v27
    v_cvt_pk_bf16_f32 v41, v26, v27
    v_mfma_f32_16x16x32_bf16 v[72:75], a[252:255], v[36:39], v[72:75]
    v_exp_f32 v32, v32
    v_mfma_f32_16x16x32_bf16 v[20:23], a[192:195], v[236:239], v[4:7]
    ds_read_b128 a[192:195], v0 offset:16896
    v_add_f32 v15, v15, v32
    v_mfma_f32_16x16x32_bf16 v[20:23], a[196:199], v[240:243], v[20:23]
    ds_read_b128 a[196:199], v0 offset:16960
    v_exp_f32 v33, v33
    v_mfma_f32_16x16x32_bf16 v[20:23], a[200:203], v[244:247], v[20:23]
    ds_read_b128 a[200:203], v0 offset:21120
    v_cvt_pk_bf16_f32 v42, v32, v33
    v_mfma_f32_16x16x32_bf16 v[20:23], a[204:207], v[248:251], v[20:23]
    v_exp_f32 v34, v34
    v_mfma_f32_16x16x32_bf16 v[28:31], a[208:211], v[236:239], v[4:7]
    ds_read_b128 a[204:207], v0 offset:21184
    ds_read_b128 a[208:211], v0 offset:17408
    v_mfma_f32_16x16x32_bf16 v[28:31], a[212:215], v[240:243], v[28:31]
    ds_read_b128 a[212:215], v0 offset:17472
    v_exp_f32 v35, v35
    v_mfma_f32_16x16x32_bf16 v[28:31], a[216:219], v[244:247], v[28:31]
    ds_read_b128 a[216:219], v0 offset:21632
    ds_read_b128 v[108:111], v2 offset:512
    v_cvt_pk_bf16_f32 v43, v34, v35
    v_mfma_f32_16x16x32_bf16 v[28:31], a[220:223], v[248:251], v[28:31]
    ds_read_b128 a[220:223], v0 offset:21696
    v_exp_f32 v20, v20
    v_mfma_f32_16x16x32_bf16 v[76:79], a[224:227], v[40:43], v[76:79]
    ds_read_b128 v[112:115], v2 offset:576
    ds_read_b128 v[116:119], v2 offset:4736
    v_mfma_f32_16x16x32_bf16 v[80:83], a[228:231], v[40:43], v[80:83]
    v_exp_f32 v21, v21
    v_mfma_f32_16x16x32_bf16 v[84:87], a[232:235], v[40:43], v[84:87]
    ds_read_b128 v[120:123], v2 offset:4800
    v_cvt_pk_bf16_f32 v36, v20, v21
    v_mfma_f32_16x16x32_bf16 v[88:91], a[236:239], v[40:43], v[88:91]
    v_exp_f32 v22, v22
    v_mfma_f32_16x16x32_bf16 v[92:95], a[240:243], v[40:43], v[92:95]
    v_add_f32 v15, v15, v33
    v_add_f32 v16, v16, v20
    v_mfma_f32_16x16x32_bf16 v[96:99], a[244:247], v[40:43], v[96:99]
    v_exp_f32 v23, v23
    v_mfma_f32_16x16x32_bf16 v[100:103], a[248:251], v[40:43], v[100:103]
    v_add_f32 v16, v16, v22
    v_cvt_pk_bf16_f32 v37, v22, v23
    v_mfma_f32_16x16x32_bf16 v[104:107], a[252:255], v[40:43], v[104:107]
    s_waitcnt lgkmcnt(11)
    v_exp_f32 v28, v28
    v_mfma_f32_16x16x32_bf16 v[24:27], a[192:195], v[204:207], v[4:7]
    s_waitcnt lgkmcnt(10)
    v_add_f32 v15, v15, v35
    v_add_f32 v16, v16, v21
    v_mfma_f32_16x16x32_bf16 v[24:27], a[196:199], v[208:211], v[24:27]
    s_waitcnt lgkmcnt(9)
    v_exp_f32 v29, v29
    v_mfma_f32_16x16x32_bf16 v[24:27], a[200:203], v[212:215], v[24:27]
    s_waitcnt lgkmcnt(8)
    v_add_f32 v15, v15, v34
    v_cvt_pk_bf16_f32 v38, v28, v29
    v_mfma_f32_16x16x32_bf16 v[24:27], a[204:207], v[216:219], v[24:27]
    s_waitcnt lgkmcnt(7)
    v_exp_f32 v30, v30
    v_mfma_f32_16x16x32_bf16 v[32:35], a[208:211], v[204:207], v[4:7]
    s_waitcnt lgkmcnt(6)
    v_add_f32 v16, v16, v29
    v_add_f32 v16, v16, v30
    v_mfma_f32_16x16x32_bf16 v[32:35], a[212:215], v[208:211], v[32:35]
    s_waitcnt lgkmcnt(5)
    v_exp_f32 v31, v31
    v_mfma_f32_16x16x32_bf16 v[32:35], a[216:219], v[212:215], v[32:35]
    s_waitcnt lgkmcnt(3)
    v_add_f32 v16, v16, v23
    v_cvt_pk_bf16_f32 v39, v30, v31
    v_mfma_f32_16x16x32_bf16 v[32:35], a[220:223], v[216:219], v[32:35]
    v_exp_f32 v24, v24
    v_mfma_f32_16x16x32_bf16 v[124:127], a[224:227], v[36:39], v[124:127]
    ds_read_b64_tr_b16 a[224:225], v1 offset:16896
    ds_read_b64_tr_b16 a[226:227], v1 offset:17408
    v_mfma_f32_16x16x32_bf16 v[128:131], a[228:231], v[36:39], v[128:131]
    ds_read_b64_tr_b16 a[230:231], v1 offset:17440
    v_exp_f32 v25, v25
    v_mfma_f32_16x16x32_bf16 v[132:135], a[232:235], v[36:39], v[132:135]
    ds_read_b64_tr_b16 a[228:229], v1 offset:16928
    ds_read_b64_tr_b16 a[232:233], v1 offset:16960
    ds_read_b64_tr_b16 a[234:235], v1 offset:17472
    v_mfma_f32_16x16x32_bf16 v[136:139], a[236:239], v[36:39], v[136:139]
    ds_read_b64_tr_b16 a[238:239], v1 offset:17504
    v_exp_f32 v26, v26
    v_mfma_f32_16x16x32_bf16 v[140:143], a[240:243], v[36:39], v[140:143]
    ds_read_b64_tr_b16 a[236:237], v1 offset:16992
    ds_read_b64_tr_b16 a[240:241], v1 offset:21120
    ds_read_b64_tr_b16 a[242:243], v1 offset:21632
    v_mfma_f32_16x16x32_bf16 v[144:147], a[244:247], v[36:39], v[144:147]
    v_exp_f32 v27, v27
    v_mfma_f32_16x16x32_bf16 v[148:151], a[248:251], v[36:39], v[148:151]
    ds_read_b64_tr_b16 a[244:245], v1 offset:21152
    ds_read_b64_tr_b16 a[250:251], v1 offset:21696
    v_mfma_f32_16x16x32_bf16 v[152:155], a[252:255], v[36:39], v[152:155]
    v_exp_f32 v32, v32
    v_mfma_f32_16x16x32_bf16 v[20:23], a[192:195], v[108:111], v[4:7]
    s_waitcnt lgkmcnt(14)
    ds_read_b64_tr_b16 a[246:247], v1 offset:21664
    ds_read_b64_tr_b16 a[248:249], v1 offset:21184
    v_mfma_f32_16x16x32_bf16 v[20:23], a[196:199], v[112:115], v[20:23]
    s_waitcnt lgkmcnt(15)
    v_exp_f32 v33, v33
    v_mfma_f32_16x16x32_bf16 v[20:23], a[200:203], v[116:119], v[20:23]
    s_waitcnt lgkmcnt(14)
    v_add_f32 v16, v16, v28
    v_add_f32 v16, v16, v31
    v_mfma_f32_16x16x32_bf16 v[20:23], a[204:207], v[120:123], v[20:23]
    v_exp_f32 v34, v34
    v_mfma_f32_16x16x32_bf16 v[28:31], a[208:211], v[108:111], v[4:7]
    v_cvt_pk_bf16_f32 v41, v26, v27
    v_cvt_pk_bf16_f32 v42, v32, v33
    v_mfma_f32_16x16x32_bf16 v[28:31], a[212:215], v[112:115], v[28:31]
    v_exp_f32 v35, v35
    v_mfma_f32_16x16x32_bf16 v[28:31], a[216:219], v[116:119], v[28:31]
    v_cvt_pk_bf16_f32 v40, v24, v25
    v_cvt_pk_bf16_f32 v43, v34, v35
    v_mfma_f32_16x16x32_bf16 v[28:31], a[220:223], v[120:123], v[28:31]
    s_waitcnt lgkmcnt(12)
    v_exp_f32 v20, v20
    v_mfma_f32_16x16x32_bf16 a[128:131], a[224:227], v[40:43], a[128:131]
    s_waitcnt lgkmcnt(10)
    ds_read_b64_tr_b16 a[252:253], v1 offset:21216
    ds_read_b64_tr_b16 a[254:255], v1 offset:21728
    v_mfma_f32_16x16x32_bf16 a[132:135], a[228:231], v[40:43], a[132:135]
    s_waitcnt lgkmcnt(10)
    v_exp_f32 v21, v21
    v_mfma_f32_16x16x32_bf16 a[136:139], a[232:235], v[40:43], a[136:139]
    s_waitcnt lgkmcnt(8)
    ds_read_b128 v[112:115], v2 offset:8512
    ds_read_b128 v[116:119], v2 offset:12672
    v_mfma_f32_16x16x32_bf16 a[140:143], a[236:239], v[40:43], a[140:143]
    s_waitcnt lgkmcnt(8)
    v_exp_f32 v22, v22
    v_mfma_f32_16x16x32_bf16 a[144:147], a[240:243], v[40:43], a[144:147]
    s_waitcnt lgkmcnt(5)
    v_add_f32 v12, v12, v24
    v_add_f32 v12, v12, v27
    v_mfma_f32_16x16x32_bf16 a[148:151], a[244:247], v[40:43], a[148:151]
    s_waitcnt lgkmcnt(4)
    v_exp_f32 v23, v23
    v_mfma_f32_16x16x32_bf16 a[152:155], a[248:251], v[40:43], a[152:155]
    s_waitcnt lgkmcnt(2)
    v_add_f32 v12, v12, v25
    v_add_f32 v12, v12, v26
    v_mfma_f32_16x16x32_bf16 a[156:159], a[252:255], v[40:43], a[156:159]
    v_exp_f32 v28, v28
    v_mfma_f32_16x16x32_bf16 v[24:27], a[192:195], v[220:223], v[4:7]
    v_add_f32 v12, v12, v33
    v_add_f32 v12, v12, v34
    v_mfma_f32_16x16x32_bf16 v[24:27], a[196:199], v[224:227], v[24:27]
    v_exp_f32 v29, v29
    v_mfma_f32_16x16x32_bf16 v[24:27], a[200:203], v[228:231], v[24:27]
    v_add_f32 v12, v12, v32
    v_add_f32 v12, v12, v35
    v_mfma_f32_16x16x32_bf16 v[24:27], a[204:207], v[232:235], v[24:27]
    v_exp_f32 v30, v30
    v_mov_b32 v252, v12
    v_accvgpr_read_b32 v156, a128
    v_accvgpr_read_b32 v157, a129
    v_permlane32_swap_b32 v12, v252
    v_accvgpr_read_b32 v158, a130
    v_add_f32 v12, v12, v252
    v_mov_b32 v252, v12
    v_accvgpr_read_b32 v159, a131
    v_accvgpr_read_b32 v160, a132
    v_permlane16_swap_b32 v12, v252
    v_accvgpr_read_b32 v161, a133
    v_add_f32 v12, v12, v252
    v_rcp_f32 v254, v12
    v_cmp_nle_f32 vcc, s48, v12
    v_cmp_nge_f32 s[46:47], s49, v12
    v_accvgpr_read_b32 v162, a134
    v_accvgpr_read_b32 v163, a135
    s_add_u32 s36, s25, 16384
    s_or_b64 s[32:33], s[32:33], vcc
    s_or_b64 s[32:33], s[32:33], s[46:47]
    v_pk_mul_f32 v[156:157], v[156:157], v[254:255] op_sel_hi:[1,0]
    v_pk_mul_f32 v[158:159], v[158:159], v[254:255] op_sel_hi:[1,0]
    v_pk_mul_f32 v[160:161], v[160:161], v[254:255] op_sel_hi:[1,0]
    v_pk_mul_f32 v[162:163], v[162:163], v[254:255] op_sel_hi:[1,0]
    v_cvt_pk_bf16_f32 v172, v156, v157
    v_cvt_pk_bf16_f32 v173, v158, v159
    v_cvt_pk_bf16_f32 v174, v160, v161
    v_cvt_pk_bf16_f32 v175, v162, v163
    v_accvgpr_read_b32 v164, a136
    v_accvgpr_read_b32 v165, a137
    v_accvgpr_read_b32 v166, a138
    v_accvgpr_read_b32 v167, a139
    v_accvgpr_read_b32 v168, a140
    v_accvgpr_read_b32 v169, a141
    v_accvgpr_read_b32 v170, a142
    v_accvgpr_read_b32 v171, a143
    v_permlane16_swap_b32 v172, v174
    v_permlane16_swap_b32 v173, v175
    v_pk_mul_f32 v[164:165], v[164:165], v[254:255] op_sel_hi:[1,0]
    v_pk_mul_f32 v[166:167], v[166:167], v[254:255] op_sel_hi:[1,0]
    v_pk_mul_f32 v[168:169], v[168:169], v[254:255] op_sel_hi:[1,0]
    v_pk_mul_f32 v[170:171], v[170:171], v[254:255] op_sel_hi:[1,0]
    v_cvt_pk_bf16_f32 v176, v164, v165
    v_cvt_pk_bf16_f32 v177, v166, v167
    v_cvt_pk_bf16_f32 v178, v168, v169
    v_cvt_pk_bf16_f32 v179, v170, v171
    buffer_store_dwordx4 v[172:175], v19, s[20:23], s36 offen offset:0 sc1
    v_accvgpr_read_b32 v156, a144
    v_accvgpr_read_b32 v157, a145
    v_accvgpr_read_b32 v158, a146
    v_accvgpr_read_b32 v159, a147
    v_accvgpr_read_b32 v160, a148
    v_accvgpr_read_b32 v161, a149
    v_accvgpr_read_b32 v162, a150
    v_accvgpr_read_b32 v163, a151
    v_permlane16_swap_b32 v176, v178
    v_permlane16_swap_b32 v177, v179
    v_pk_mul_f32 v[156:157], v[156:157], v[254:255] op_sel_hi:[1,0]
    v_pk_mul_f32 v[158:159], v[158:159], v[254:255] op_sel_hi:[1,0]
    v_pk_mul_f32 v[160:161], v[160:161], v[254:255] op_sel_hi:[1,0]
    v_pk_mul_f32 v[162:163], v[162:163], v[254:255] op_sel_hi:[1,0]
    v_cvt_pk_bf16_f32 v180, v156, v157
    v_cvt_pk_bf16_f32 v181, v158, v159
    v_cvt_pk_bf16_f32 v182, v160, v161
    v_cvt_pk_bf16_f32 v183, v162, v163
    buffer_store_dwordx4 v[176:179], v19, s[20:23], s36 offen offset:64 sc1
    v_accvgpr_read_b32 v164, a152
    v_accvgpr_read_b32 v165, a153
    v_accvgpr_read_b32 v166, a154
    v_accvgpr_read_b32 v167, a155
    v_accvgpr_read_b32 v168, a156
    v_accvgpr_read_b32 v169, a157
    v_accvgpr_read_b32 v170, a158
    v_accvgpr_read_b32 v171, a159
    v_permlane16_swap_b32 v180, v182
    v_permlane16_swap_b32 v181, v183
    v_pk_mul_f32 v[164:165], v[164:165], v[254:255] op_sel_hi:[1,0]
    v_pk_mul_f32 v[166:167], v[166:167], v[254:255] op_sel_hi:[1,0]
    v_pk_mul_f32 v[168:169], v[168:169], v[254:255] op_sel_hi:[1,0]
    v_pk_mul_f32 v[170:171], v[170:171], v[254:255] op_sel_hi:[1,0]
    v_cvt_pk_bf16_f32 v184, v164, v165
    v_cvt_pk_bf16_f32 v185, v166, v167
    v_cvt_pk_bf16_f32 v186, v168, v169
    v_cvt_pk_bf16_f32 v187, v170, v171
    buffer_store_dwordx4 v[180:183], v19, s[20:23], s36 offen offset:128 sc1
    s_nop 0
    v_permlane16_swap_b32 v184, v186
    v_permlane16_swap_b32 v185, v187
    s_nop 1
    buffer_store_dwordx4 v[184:187], v19, s[20:23], s36 offen offset:192 sc1
    v_mfma_f32_16x16x32_bf16 v[32:35], a[208:211], v[220:223], v[4:7]
    v_cvt_pk_bf16_f32 v37, v22, v23
    v_cvt_pk_bf16_f32 v38, v28, v29
    v_mfma_f32_16x16x32_bf16 v[32:35], a[212:215], v[224:227], v[32:35]
    v_exp_f32 v31, v31
    v_mfma_f32_16x16x32_bf16 v[32:35], a[216:219], v[228:231], v[32:35]
    v_cvt_pk_bf16_f32 v36, v20, v21
    v_cvt_pk_bf16_f32 v39, v30, v31
    v_mfma_f32_16x16x32_bf16 v[32:35], a[220:223], v[232:235], v[32:35]
    v_exp_f32 v24, v24
    v_mfma_f32_16x16x32_bf16 a[160:163], a[224:227], v[36:39], a[160:163]
    ds_read_b128 v[108:111], v2 offset:8448
    ds_read_b128 v[120:123], v2 offset:12736
    v_mfma_f32_16x16x32_bf16 a[164:167], a[228:231], v[36:39], a[164:167]
    v_exp_f32 v25, v25
    v_mfma_f32_16x16x32_bf16 a[168:171], a[232:235], v[36:39], a[168:171]
    v_add_f32 v13, v13, v23
    v_cvt_pk_bf16_f32 v40, v24, v25
    v_mfma_f32_16x16x32_bf16 a[172:175], a[236:239], v[36:39], a[172:175]
    v_exp_f32 v26, v26
    v_mfma_f32_16x16x32_bf16 a[176:179], a[240:243], v[36:39], a[176:179]
    v_add_f32 v13, v13, v20
    v_add_f32 v13, v13, v21
    v_mfma_f32_16x16x32_bf16 a[180:183], a[244:247], v[36:39], a[180:183]
    v_exp_f32 v27, v27
    v_mfma_f32_16x16x32_bf16 a[184:187], a[248:251], v[36:39], a[184:187]
    v_add_f32 v13, v13, v22
    v_cvt_pk_bf16_f32 v41, v26, v27
    v_mfma_f32_16x16x32_bf16 a[188:191], a[252:255], v[36:39], a[188:191]
    s_waitcnt lgkmcnt(1)
    v_exp_f32 v32, v32
    v_mfma_f32_16x16x32_bf16 v[20:23], a[192:195], v[108:111], v[4:7]
    v_add_f32 v13, v13, v30
    v_add_f32 v13, v13, v31
    v_mfma_f32_16x16x32_bf16 v[20:23], a[196:199], v[112:115], v[20:23]
    v_exp_f32 v33, v33
    v_mfma_f32_16x16x32_bf16 v[20:23], a[200:203], v[116:119], v[20:23]
    s_waitcnt lgkmcnt(0)
    s_waitcnt vmcnt(20)
    s_barrier
    v_add_f32 v13, v13, v28
    v_add_f32 v13, v13, v29
    v_mfma_f32_16x16x32_bf16 v[20:23], a[204:207], v[120:123], v[20:23]
    v_exp_f32 v34, v34
    v_mov_b32 v252, v13
    v_accvgpr_read_b32 v156, a160
    v_accvgpr_read_b32 v157, a161
    v_permlane32_swap_b32 v13, v252
    v_accvgpr_read_b32 v158, a162
    v_add_f32 v13, v13, v252
    v_mov_b32 v252, v13
    v_accvgpr_read_b32 v159, a163
    v_accvgpr_read_b32 v160, a164
    v_permlane16_swap_b32 v13, v252
    v_accvgpr_read_b32 v161, a165
    v_add_f32 v13, v13, v252
    v_rcp_f32 v254, v13
    v_cmp_nle_f32 vcc, s48, v13
    v_cmp_nge_f32 s[46:47], s49, v13
    v_accvgpr_read_b32 v162, a166
    v_accvgpr_read_b32 v163, a167
    s_add_u32 s36, s25, 20480
    s_or_b64 s[32:33], s[32:33], vcc
    s_or_b64 s[32:33], s[32:33], s[46:47]
    v_pk_mul_f32 v[156:157], v[156:157], v[254:255] op_sel_hi:[1,0]
    v_pk_mul_f32 v[158:159], v[158:159], v[254:255] op_sel_hi:[1,0]
    v_pk_mul_f32 v[160:161], v[160:161], v[254:255] op_sel_hi:[1,0]
    v_pk_mul_f32 v[162:163], v[162:163], v[254:255] op_sel_hi:[1,0]
    v_cvt_pk_bf16_f32 v172, v156, v157
    v_cvt_pk_bf16_f32 v173, v158, v159
    v_cvt_pk_bf16_f32 v174, v160, v161
    v_cvt_pk_bf16_f32 v175, v162, v163
    v_accvgpr_read_b32 v164, a168
    v_accvgpr_read_b32 v165, a169
    v_accvgpr_read_b32 v166, a170
    v_accvgpr_read_b32 v167, a171
    v_accvgpr_read_b32 v168, a172
    v_accvgpr_read_b32 v169, a173
    v_accvgpr_read_b32 v170, a174
    v_accvgpr_read_b32 v171, a175
    v_permlane16_swap_b32 v172, v174
    v_permlane16_swap_b32 v173, v175
    v_pk_mul_f32 v[164:165], v[164:165], v[254:255] op_sel_hi:[1,0]
    v_pk_mul_f32 v[166:167], v[166:167], v[254:255] op_sel_hi:[1,0]
    v_pk_mul_f32 v[168:169], v[168:169], v[254:255] op_sel_hi:[1,0]
    v_pk_mul_f32 v[170:171], v[170:171], v[254:255] op_sel_hi:[1,0]
    v_cvt_pk_bf16_f32 v176, v164, v165
    v_cvt_pk_bf16_f32 v177, v166, v167
    v_cvt_pk_bf16_f32 v178, v168, v169
    v_cvt_pk_bf16_f32 v179, v170, v171
    buffer_store_dwordx4 v[172:175], v19, s[20:23], s36 offen offset:0 sc1
    v_accvgpr_read_b32 v156, a176
    v_accvgpr_read_b32 v157, a177
    v_accvgpr_read_b32 v158, a178
    v_accvgpr_read_b32 v159, a179
    v_accvgpr_read_b32 v160, a180
    v_accvgpr_read_b32 v161, a181
    v_accvgpr_read_b32 v162, a182
    v_accvgpr_read_b32 v163, a183
    v_permlane16_swap_b32 v176, v178
    v_permlane16_swap_b32 v177, v179
    v_pk_mul_f32 v[156:157], v[156:157], v[254:255] op_sel_hi:[1,0]
    v_pk_mul_f32 v[158:159], v[158:159], v[254:255] op_sel_hi:[1,0]
    v_pk_mul_f32 v[160:161], v[160:161], v[254:255] op_sel_hi:[1,0]
    v_pk_mul_f32 v[162:163], v[162:163], v[254:255] op_sel_hi:[1,0]
    v_cvt_pk_bf16_f32 v180, v156, v157
    v_cvt_pk_bf16_f32 v181, v158, v159
    v_cvt_pk_bf16_f32 v182, v160, v161
    v_cvt_pk_bf16_f32 v183, v162, v163
    buffer_store_dwordx4 v[176:179], v19, s[20:23], s36 offen offset:64 sc1
    v_accvgpr_read_b32 v164, a184
    v_accvgpr_read_b32 v165, a185
    v_accvgpr_read_b32 v166, a186
    v_accvgpr_read_b32 v167, a187
    v_accvgpr_read_b32 v168, a188
    v_accvgpr_read_b32 v169, a189
    v_accvgpr_read_b32 v170, a190
    v_accvgpr_read_b32 v171, a191
    v_permlane16_swap_b32 v180, v182
    v_permlane16_swap_b32 v181, v183
    v_pk_mul_f32 v[164:165], v[164:165], v[254:255] op_sel_hi:[1,0]
    v_pk_mul_f32 v[166:167], v[166:167], v[254:255] op_sel_hi:[1,0]
    v_pk_mul_f32 v[168:169], v[168:169], v[254:255] op_sel_hi:[1,0]
    v_pk_mul_f32 v[170:171], v[170:171], v[254:255] op_sel_hi:[1,0]
    v_cvt_pk_bf16_f32 v184, v164, v165
    v_cvt_pk_bf16_f32 v185, v166, v167
    v_cvt_pk_bf16_f32 v186, v168, v169
    v_cvt_pk_bf16_f32 v187, v170, v171
    buffer_store_dwordx4 v[180:183], v19, s[20:23], s36 offen offset:128 sc1
    s_nop 0
    v_permlane16_swap_b32 v184, v186
    v_permlane16_swap_b32 v185, v187
    s_nop 1
    buffer_store_dwordx4 v[184:187], v19, s[20:23], s36 offen offset:192 sc1
    v_mfma_f32_16x16x32_bf16 v[28:31], a[208:211], v[108:111], v[4:7]
    v_add_f32 v14, v14, v34
    v_cvt_pk_bf16_f32 v42, v32, v33
    v_mfma_f32_16x16x32_bf16 v[28:31], a[212:215], v[112:115], v[28:31]
    v_exp_f32 v35, v35
    v_mfma_f32_16x16x32_bf16 v[28:31], a[216:219], v[116:119], v[28:31]
    v_add_f32 v14, v14, v26
    v_cvt_pk_bf16_f32 v43, v34, v35
    v_mfma_f32_16x16x32_bf16 v[28:31], a[220:223], v[120:123], v[28:31]
    v_exp_f32 v20, v20
    v_mfma_f32_16x16x32_bf16 v[44:47], a[224:227], v[40:43], v[44:47]
    v_add_f32 v14, v14, v27
    v_add_f32 v15, v15, v20
    v_mfma_f32_16x16x32_bf16 v[48:51], a[228:231], v[40:43], v[48:51]
    v_exp_f32 v21, v21
    v_mfma_f32_16x16x32_bf16 v[52:55], a[232:235], v[40:43], v[52:55]
    v_add_f32 v14, v14, v32
    v_cvt_pk_bf16_f32 v36, v20, v21
    v_mfma_f32_16x16x32_bf16 v[56:59], a[236:239], v[40:43], v[56:59]
    v_exp_f32 v22, v22
    v_mfma_f32_16x16x32_bf16 v[60:63], a[240:243], v[40:43], v[60:63]
    v_add_f32 v14, v14, v24
    v_add_f32 v15, v15, v22
    v_mfma_f32_16x16x32_bf16 v[64:67], a[244:247], v[40:43], v[64:67]
    v_exp_f32 v23, v23
    v_mfma_f32_16x16x32_bf16 v[68:71], a[248:251], v[40:43], v[68:71]
    v_add_f32 v14, v14, v25
    v_cvt_pk_bf16_f32 v37, v22, v23
    v_mfma_f32_16x16x32_bf16 v[72:75], a[252:255], v[40:43], v[72:75]
    v_exp_f32 v28, v28
    v_mfma_f32_16x16x32_bf16 v[24:27], a[192:195], v[236:239], v[4:7]
    v_add_f32 v14, v14, v35
    v_add_f32 v15, v15, v28
    v_mfma_f32_16x16x32_bf16 v[24:27], a[196:199], v[240:243], v[24:27]
    v_exp_f32 v29, v29
    v_mfma_f32_16x16x32_bf16 v[24:27], a[200:203], v[244:247], v[24:27]
    v_add_f32 v14, v14, v33
    v_cvt_pk_bf16_f32 v38, v28, v29
    v_mfma_f32_16x16x32_bf16 v[24:27], a[204:207], v[248:251], v[24:27]
    v_exp_f32 v30, v30
    v_mov_b32 v252, v14
    s_nop 0
    s_nop 0
    v_permlane32_swap_b32 v14, v252
    s_nop 0
    v_add_f32 v14, v14, v252
    v_mov_b32 v252, v14
    s_nop 0
    s_nop 0
    v_permlane16_swap_b32 v14, v252
    s_nop 0
    v_add_f32 v14, v14, v252
    v_rcp_f32 v254, v14
    v_cmp_nle_f32 vcc, s48, v14
    v_cmp_nge_f32 s[46:47], s49, v14
    s_nop 0
    s_nop 0
    s_add_u32 s36, s25, 24576
    s_or_b64 s[32:33], s[32:33], vcc
    s_or_b64 s[32:33], s[32:33], s[46:47]
    v_pk_mul_f32 v[156:157], v[44:45], v[254:255] op_sel_hi:[1,0]
    v_pk_mul_f32 v[158:159], v[46:47], v[254:255] op_sel_hi:[1,0]
    v_pk_mul_f32 v[160:161], v[48:49], v[254:255] op_sel_hi:[1,0]
    v_pk_mul_f32 v[162:163], v[50:51], v[254:255] op_sel_hi:[1,0]
    v_cvt_pk_bf16_f32 v172, v156, v157
    v_cvt_pk_bf16_f32 v173, v158, v159
    v_cvt_pk_bf16_f32 v174, v160, v161
    v_cvt_pk_bf16_f32 v175, v162, v163
    s_nop 1
    v_permlane16_swap_b32 v172, v174
    v_permlane16_swap_b32 v173, v175
    v_pk_mul_f32 v[164:165], v[52:53], v[254:255] op_sel_hi:[1,0]
    v_pk_mul_f32 v[166:167], v[54:55], v[254:255] op_sel_hi:[1,0]
    v_pk_mul_f32 v[168:169], v[56:57], v[254:255] op_sel_hi:[1,0]
    v_pk_mul_f32 v[170:171], v[58:59], v[254:255] op_sel_hi:[1,0]
    v_cvt_pk_bf16_f32 v176, v164, v165
    v_cvt_pk_bf16_f32 v177, v166, v167
    v_cvt_pk_bf16_f32 v178, v168, v169
    v_cvt_pk_bf16_f32 v179, v170, v171
    buffer_store_dwordx4 v[172:175], v19, s[20:23], s36 offen offset:0 sc1
    s_nop 1
    v_permlane16_swap_b32 v176, v178
    v_permlane16_swap_b32 v177, v179
    v_pk_mul_f32 v[156:157], v[60:61], v[254:255] op_sel_hi:[1,0]
    v_pk_mul_f32 v[158:159], v[62:63], v[254:255] op_sel_hi:[1,0]
    v_pk_mul_f32 v[160:161], v[64:65], v[254:255] op_sel_hi:[1,0]
    v_pk_mul_f32 v[162:163], v[66:67], v[254:255] op_sel_hi:[1,0]
    v_cvt_pk_bf16_f32 v180, v156, v157
    v_cvt_pk_bf16_f32 v181, v158, v159
    v_cvt_pk_bf16_f32 v182, v160, v161
    v_cvt_pk_bf16_f32 v183, v162, v163
    buffer_store_dwordx4 v[176:179], v19, s[20:23], s36 offen offset:64 sc1
    s_nop 1
    v_permlane16_swap_b32 v180, v182
    v_permlane16_swap_b32 v181, v183
    v_pk_mul_f32 v[164:165], v[68:69], v[254:255] op_sel_hi:[1,0]
    v_pk_mul_f32 v[166:167], v[70:71], v[254:255] op_sel_hi:[1,0]
    v_pk_mul_f32 v[168:169], v[72:73], v[254:255] op_sel_hi:[1,0]
    v_pk_mul_f32 v[170:171], v[74:75], v[254:255] op_sel_hi:[1,0]
    v_cvt_pk_bf16_f32 v184, v164, v165
    v_cvt_pk_bf16_f32 v185, v166, v167
    v_cvt_pk_bf16_f32 v186, v168, v169
    v_cvt_pk_bf16_f32 v187, v170, v171
    buffer_store_dwordx4 v[180:183], v19, s[20:23], s36 offen offset:128 sc1
    s_nop 0
    v_permlane16_swap_b32 v184, v186
    v_permlane16_swap_b32 v185, v187
    s_nop 1
    buffer_store_dwordx4 v[184:187], v19, s[20:23], s36 offen offset:192 sc1
    v_mfma_f32_16x16x32_bf16 v[32:35], a[208:211], v[236:239], v[4:7]
    v_add_f32 v15, v15, v21
    v_add_f32 v15, v15, v30
    v_mfma_f32_16x16x32_bf16 v[32:35], a[212:215], v[240:243], v[32:35]
    v_exp_f32 v31, v31
    v_mfma_f32_16x16x32_bf16 v[32:35], a[216:219], v[244:247], v[32:35]
    v_add_f32 v15, v15, v31
    v_cvt_pk_bf16_f32 v39, v30, v31
    v_mfma_f32_16x16x32_bf16 v[32:35], a[220:223], v[248:251], v[32:35]
    v_exp_f32 v24, v24
    v_mfma_f32_16x16x32_bf16 v[76:79], a[224:227], v[36:39], v[76:79]
    v_add_f32 v15, v15, v29
    v_add_f32 v16, v16, v24
    v_mfma_f32_16x16x32_bf16 v[80:83], a[228:231], v[36:39], v[80:83]
    v_exp_f32 v25, v25
    v_mfma_f32_16x16x32_bf16 v[84:87], a[232:235], v[36:39], v[84:87]
    v_add_f32 v16, v16, v25
    v_cvt_pk_bf16_f32 v40, v24, v25
    v_mfma_f32_16x16x32_bf16 v[88:91], a[236:239], v[36:39], v[88:91]
    v_exp_f32 v26, v26
    v_mfma_f32_16x16x32_bf16 v[92:95], a[240:243], v[36:39], v[92:95]
    v_add_f32 v15, v15, v23
    v_add_f32 v16, v16, v26
    v_mfma_f32_16x16x32_bf16 v[96:99], a[244:247], v[36:39], v[96:99]
    v_exp_f32 v27, v27
    v_mfma_f32_16x16x32_bf16 v[100:103], a[248:251], v[36:39], v[100:103]
    v_add_f32 v16, v16, v27
    v_cvt_pk_bf16_f32 v41, v26, v27
    v_mfma_f32_16x16x32_bf16 v[104:107], a[252:255], v[36:39], v[104:107]
    v_exp_f32 v32, v32
    s_nop 1
    v_add_f32 v16, v16, v32
    s_nop 1
    v_exp_f32 v33, v33
    s_nop 1
    v_add_f32 v16, v16, v33
    v_cvt_pk_bf16_f32 v42, v32, v33
    s_nop 1
    v_exp_f32 v34, v34
    v_mov_b32 v252, v15
    s_nop 0
    s_nop 0
    v_permlane32_swap_b32 v15, v252
    s_nop 0
    v_add_f32 v15, v15, v252
    v_mov_b32 v252, v15
    s_nop 0
    s_nop 0
    v_permlane16_swap_b32 v15, v252
    s_nop 0
    v_add_f32 v15, v15, v252
    v_rcp_f32 v254, v15
    v_cmp_nle_f32 vcc, s48, v15
    v_cmp_nge_f32 s[46:47], s49, v15
    s_nop 0
    s_nop 0
    s_add_u32 s36, s25, 28672
    s_or_b64 s[32:33], s[32:33], vcc
    s_or_b64 s[32:33], s[32:33], s[46:47]
    v_pk_mul_f32 v[156:157], v[76:77], v[254:255] op_sel_hi:[1,0]
    v_pk_mul_f32 v[158:159], v[78:79], v[254:255] op_sel_hi:[1,0]
    v_pk_mul_f32 v[160:161], v[80:81], v[254:255] op_sel_hi:[1,0]
    v_pk_mul_f32 v[162:163], v[82:83], v[254:255] op_sel_hi:[1,0]
    v_cvt_pk_bf16_f32 v172, v156, v157
    v_cvt_pk_bf16_f32 v173, v158, v159
    v_cvt_pk_bf16_f32 v174, v160, v161
    v_cvt_pk_bf16_f32 v175, v162, v163
    s_nop 1
    v_permlane16_swap_b32 v172, v174
    v_permlane16_swap_b32 v173, v175
    v_pk_mul_f32 v[164:165], v[84:85], v[254:255] op_sel_hi:[1,0]
    v_pk_mul_f32 v[166:167], v[86:87], v[254:255] op_sel_hi:[1,0]
    v_pk_mul_f32 v[168:169], v[88:89], v[254:255] op_sel_hi:[1,0]
    v_pk_mul_f32 v[170:171], v[90:91], v[254:255] op_sel_hi:[1,0]
    v_cvt_pk_bf16_f32 v176, v164, v165
    v_cvt_pk_bf16_f32 v177, v166, v167
    v_cvt_pk_bf16_f32 v178, v168, v169
    v_cvt_pk_bf16_f32 v179, v170, v171
    buffer_store_dwordx4 v[172:175], v19, s[20:23], s36 offen offset:0 sc1
    s_nop 1
    v_permlane16_swap_b32 v176, v178
    v_permlane16_swap_b32 v177, v179
    v_pk_mul_f32 v[156:157], v[92:93], v[254:255] op_sel_hi:[1,0]
    v_pk_mul_f32 v[158:159], v[94:95], v[254:255] op_sel_hi:[1,0]
    v_pk_mul_f32 v[160:161], v[96:97], v[254:255] op_sel_hi:[1,0]
    v_pk_mul_f32 v[162:163], v[98:99], v[254:255] op_sel_hi:[1,0]
    v_cvt_pk_bf16_f32 v180, v156, v157
    v_cvt_pk_bf16_f32 v181, v158, v159
    v_cvt_pk_bf16_f32 v182, v160, v161
    v_cvt_pk_bf16_f32 v183, v162, v163
    buffer_store_dwordx4 v[176:179], v19, s[20:23], s36 offen offset:64 sc1
    s_nop 1
    v_permlane16_swap_b32 v180, v182
    v_permlane16_swap_b32 v181, v183
    v_pk_mul_f32 v[164:165], v[100:101], v[254:255] op_sel_hi:[1,0]
    v_pk_mul_f32 v[166:167], v[102:103], v[254:255] op_sel_hi:[1,0]
    v_pk_mul_f32 v[168:169], v[104:105], v[254:255] op_sel_hi:[1,0]
    v_pk_mul_f32 v[170:171], v[106:107], v[254:255] op_sel_hi:[1,0]
    v_cvt_pk_bf16_f32 v184, v164, v165
    v_cvt_pk_bf16_f32 v185, v166, v167
    v_cvt_pk_bf16_f32 v186, v168, v169
    v_cvt_pk_bf16_f32 v187, v170, v171
    buffer_store_dwordx4 v[180:183], v19, s[20:23], s36 offen offset:128 sc1
    s_nop 0
    v_permlane16_swap_b32 v184, v186
    v_permlane16_swap_b32 v185, v187
    s_nop 1
    buffer_store_dwordx4 v[184:187], v19, s[20:23], s36 offen offset:192 sc1
    s_nop 1
    v_add_f32 v16, v16, v34
    s_nop 1
    v_exp_f32 v35, v35
    s_nop 1
    v_add_f32 v16, v16, v35
    v_cvt_pk_bf16_f32 v43, v34, v35
    s_nop 1
    v_mfma_f32_16x16x32_bf16 v[124:127], a[224:227], v[40:43], v[124:127]
    v_mfma_f32_16x16x32_bf16 v[128:131], a[228:231], v[40:43], v[128:131]
    v_mfma_f32_16x16x32_bf16 v[132:135], a[232:235], v[40:43], v[132:135]
    v_mfma_f32_16x16x32_bf16 v[136:139], a[236:239], v[40:43], v[136:139]
    v_mfma_f32_16x16x32_bf16 v[140:143], a[240:243], v[40:43], v[140:143]
    v_mfma_f32_16x16x32_bf16 v[144:147], a[244:247], v[40:43], v[144:147]
    v_mfma_f32_16x16x32_bf16 v[148:151], a[248:251], v[40:43], v[148:151]
    v_mfma_f32_16x16x32_bf16 v[152:155], a[252:255], v[40:43], v[152:155]
    s_nop 7
    s_nop 1
    v_mov_b32 v252, v16
    s_nop 0
    s_nop 0
    v_permlane32_swap_b32 v16, v252
    s_nop 0
    v_add_f32 v16, v16, v252
    v_mov_b32 v252, v16
    s_nop 0
    s_nop 0
    v_permlane16_swap_b32 v16, v252
    s_nop 0
    v_add_f32 v16, v16, v252
    v_rcp_f32 v254, v16
    v_cmp_nle_f32 vcc, s48, v16
    v_cmp_nge_f32 s[46:47], s49, v16
    s_nop 0
    s_nop 0
    s_add_u32 s36, s25, 32768
    s_or_b64 s[32:33], s[32:33], vcc
    s_or_b64 s[32:33], s[32:33], s[46:47]
    v_pk_mul_f32 v[156:157], v[124:125], v[254:255] op_sel_hi:[1,0]
    v_pk_mul_f32 v[158:159], v[126:127], v[254:255] op_sel_hi:[1,0]
    v_pk_mul_f32 v[160:161], v[128:129], v[254:255] op_sel_hi:[1,0]
    v_pk_mul_f32 v[162:163], v[130:131], v[254:255] op_sel_hi:[1,0]
    v_cvt_pk_bf16_f32 v172, v156, v157
    v_cvt_pk_bf16_f32 v173, v158, v159
    v_cvt_pk_bf16_f32 v174, v160, v161
    v_cvt_pk_bf16_f32 v175, v162, v163
    s_nop 1
    v_permlane16_swap_b32 v172, v174
    v_permlane16_swap_b32 v173, v175
    v_pk_mul_f32 v[164:165], v[132:133], v[254:255] op_sel_hi:[1,0]
    v_pk_mul_f32 v[166:167], v[134:135], v[254:255] op_sel_hi:[1,0]
    v_pk_mul_f32 v[168:169], v[136:137], v[254:255] op_sel_hi:[1,0]
    v_pk_mul_f32 v[170:171], v[138:139], v[254:255] op_sel_hi:[1,0]
    v_cvt_pk_bf16_f32 v176, v164, v165
    v_cvt_pk_bf16_f32 v177, v166, v167
    v_cvt_pk_bf16_f32 v178, v168, v169
    v_cvt_pk_bf16_f32 v179, v170, v171
    buffer_store_dwordx4 v[172:175], v19, s[20:23], s36 offen offset:0 sc1
    s_nop 1
    v_permlane16_swap_b32 v176, v178
    v_permlane16_swap_b32 v177, v179
    v_pk_mul_f32 v[156:157], v[140:141], v[254:255] op_sel_hi:[1,0]
    v_pk_mul_f32 v[158:159], v[142:143], v[254:255] op_sel_hi:[1,0]
    v_pk_mul_f32 v[160:161], v[144:145], v[254:255] op_sel_hi:[1,0]
    v_pk_mul_f32 v[162:163], v[146:147], v[254:255] op_sel_hi:[1,0]
    v_cvt_pk_bf16_f32 v180, v156, v157
    v_cvt_pk_bf16_f32 v181, v158, v159
    v_cvt_pk_bf16_f32 v182, v160, v161
    v_cvt_pk_bf16_f32 v183, v162, v163
    buffer_store_dwordx4 v[176:179], v19, s[20:23], s36 offen offset:64 sc1
    s_nop 1
    v_permlane16_swap_b32 v180, v182
    v_permlane16_swap_b32 v181, v183
    v_pk_mul_f32 v[164:165], v[148:149], v[254:255] op_sel_hi:[1,0]
    v_pk_mul_f32 v[166:167], v[150:151], v[254:255] op_sel_hi:[1,0]
    v_pk_mul_f32 v[168:169], v[152:153], v[254:255] op_sel_hi:[1,0]
    v_pk_mul_f32 v[170:171], v[154:155], v[254:255] op_sel_hi:[1,0]
    v_cvt_pk_bf16_f32 v184, v164, v165
    v_cvt_pk_bf16_f32 v185, v166, v167
    v_cvt_pk_bf16_f32 v186, v168, v169
    v_cvt_pk_bf16_f32 v187, v170, v171
    buffer_store_dwordx4 v[180:183], v19, s[20:23], s36 offen offset:128 sc1
    s_nop 0
    v_permlane16_swap_b32 v184, v186
    v_permlane16_swap_b32 v185, v187
    s_nop 1
    buffer_store_dwordx4 v[184:187], v19, s[20:23], s36 offen offset:192 sc1
    s_cmp_lg_u64 s[32:33], 0
    s_cbranch_scc1 L_fb
    s_endpgm
L_codeend:
L_fb:
    s_waitcnt vmcnt(0) lgkmcnt(0)
    v_mbcnt_lo_u32_b32 v0, -1, 0
    v_mbcnt_hi_u32_b32 v0, -1, v0

    v_lshrrev_b32 v9, 4, v0
    v_lshlrev_b32 v4, 11, v9
    v_bfe_u32 v10, v0, 3, 1
    v_lshlrev_b32 v10, 8, v10
    v_add_u32 v4, v4, v10
    v_and_b32 v10, 7, v0
    v_lshlrev_b32 v10, 4, v10
    v_add_u32 v4, v4, v10
    v_and_b32 v10, 15, v0
    v_lshlrev_b32 v5, 8, v10
    v_lshlrev_b32 v11, 4, v9
    v_add_u32 v5, v5, v11
    v_bfe_u32 v10, v0, 1, 2
    v_mul_u32_u24 v2, 1056, v10
    v_bfe_u32 v10, v0, 3, 1
    v_lshlrev_b32 v10, 8, v10
    v_add_u32 v2, v2, v10
    v_and_b32 v10, 1, v0
    v_lshlrev_b32 v10, 7, v10
    v_add_u32 v2, v2, v10
    v_add_u32 v2, v2, v11
    v_bfe_u32 v10, v0, 3, 2
    v_mul_u32_u24 v3, 1056, v10
    v_lshrrev_b32 v10, 5, v0
    v_lshlrev_b32 v10, 8, v10
    v_add_u32 v3, v3, v10
    v_bfe_u32 v10, v0, 2, 1
    v_lshlrev_b32 v10, 7, v10
    v_add_u32 v3, v3, v10
    v_and_b32 v10, 3, v0
    v_lshlrev_b32 v10, 3, v10
    v_add_u32 v3, v3, v10

    s_mul_i32 s53, s4, 40960
    v_add_u32 v2, s53, v2
    v_add_u32 v3, s53, v3
    s_mov_b32 s51, 0
L_fb_j:
    s_lshl_b32 s34, s51, 12
    s_add_u32 s34, s34, s25
    buffer_load_dwordx4 v[88:91], v5, s[8:11], s34 offen offset:0
    buffer_load_dwordx4 v[92:95], v5, s[8:11], s34 offen offset:64
    buffer_load_dwordx4 v[96:99], v5, s[8:11], s34 offen offset:128
    buffer_load_dwordx4 v[100:103], v5, s[8:11], s34 offen offset:192
    v_mov_b32 v6, 0xff800000
    v_mov_b32 v7, 0
    v_mov_b32 v104, 0
    v_mov_b32 v105, 0
    v_mov_b32 v106, 0
    v_mov_b32 v107, 0
    v_mov_b32 v108, 0
    v_mov_b32 v109, 0
    v_mov_b32 v110, 0
    v_mov_b32 v111, 0
    v_mov_b32 v112, 0
    v_mov_b32 v113, 0
    v_mov_b32 v114, 0
    v_mov_b32 v115, 0
    v_mov_b32 v116, 0
    v_mov_b32 v117, 0
    v_mov_b32 v118, 0
    v_mov_b32 v119, 0
    v_mov_b32 v120, 0
    v_mov_b32 v121, 0
    v_mov_b32 v122, 0
    v_mov_b32 v123, 0
    v_mov_b32 v124, 0
    v_mov_b32 v125, 0
    v_mov_b32 v126, 0
    v_mov_b32 v127, 0
    v_mov_b32 v128, 0
    v_mov_b32 v129, 0
    v_mov_b32 v130, 0
    v_mov_b32 v131, 0
    v_mov_b32 v132, 0
    v_mov_b32 v133, 0
    v_mov_b32 v134, 0
    v_mov_b32 v135, 0
    s_waitcnt vmcnt(0)
    v_lshlrev_b32 v9, 16, v88
    v_and_b32 v10, s50, v88
    v_mul_f32 v9, s24, v9
    v_mul_f32 v10, s24, v10
    v_cvt_pk_bf16_f32 v88, v9, v10
    v_lshlrev_b32 v9, 16, v89
    v_and_b32 v10, s50, v89
    v_mul_f32 v9, s24, v9
    v_mul_f32 v10, s24, v10
    v_cvt_pk_bf16_f32 v89, v9, v10
    v_lshlrev_b32 v9, 16, v90
    v_and_b32 v10, s50, v90
    v_mul_f32 v9, s24, v9
    v_mul_f32 v10, s24, v10
    v_cvt_pk_bf16_f32 v90, v9, v10
    v_lshlrev_b32 v9, 16, v91
    v_and_b32 v10, s50, v91
    v_mul_f32 v9, s24, v9
    v_mul_f32 v10, s24, v10
    v_cvt_pk_bf16_f32 v91, v9, v10
    v_lshlrev_b32 v9, 16, v92
    v_and_b32 v10, s50, v92
    v_mul_f32 v9, s24, v9
    v_mul_f32 v10, s24, v10
    v_cvt_pk_bf16_f32 v92, v9, v10
    v_lshlrev_b32 v9, 16, v93
    v_and_b32 v10, s50, v93
    v_mul_f32 v9, s24, v9
    v_mul_f32 v10, s24, v10
    v_cvt_pk_bf16_f32 v93, v9, v10
    v_lshlrev_b32 v9, 16, v94
    v_and_b32 v10, s50, v94
    v_mul_f32 v9, s24, v9
    v_mul_f32 v10, s24, v10
    v_cvt_pk_bf16_f32 v94, v9, v10
    v_lshlrev_b32 v9, 16, v95
    v_and_b32 v10, s50, v95
    v_mul_f32 v9, s24, v9
    v_mul_f32 v10, s24, v10
    v_cvt_pk_bf16_f32 v95, v9, v10
    v_lshlrev_b32 v9, 16, v96
    v_and_b32 v10, s50, v96
    v_mul_f32 v9, s24, v9
    v_mul_f32 v10, s24, v10
    v_cvt_pk_bf16_f32 v96, v9, v10
    v_lshlrev_b32 v9, 16, v97
    v_and_b32 v10, s50, v97
    v_mul_f32 v9, s24, v9
    v_mul_f32 v10, s24, v10
    v_cvt_pk_bf16_f32 v97, v9, v10
    v_lshlrev_b32 v9, 16, v98
    v_and_b32 v10, s50, v98
    v_mul_f32 v9, s24, v9
    v_mul_f32 v10, s24, v10
    v_cvt_pk_bf16_f32 v98, v9, v10
    v_lshlrev_b32 v9, 16, v99
    v_and_b32 v10, s50, v99
    v_mul_f32 v9, s24, v9
    v_mul_f32 v10, s24, v10
    v_cvt_pk_bf16_f32 v99, v9, v10
    v_lshlrev_b32 v9, 16, v100
    v_and_b32 v10, s50, v100
    v_mul_f32 v9, s24, v9
    v_mul_f32 v10, s24, v10
    v_cvt_pk_bf16_f32 v100, v9, v10
    v_lshlrev_b32 v9, 16, v101
    v_and_b32 v10, s50, v101
    v_mul_f32 v9, s24, v9
    v_mul_f32 v10, s24, v10
    v_cvt_pk_bf16_f32 v101, v9, v10
    v_lshlrev_b32 v9, 16, v102
    v_and_b32 v10, s50, v102
    v_mul_f32 v9, s24, v9
    v_mul_f32 v10, s24, v10
    v_cvt_pk_bf16_f32 v102, v9, v10
    v_lshlrev_b32 v9, 16, v103
    v_and_b32 v10, s50, v103
    v_mul_f32 v9, s24, v9
    v_mul_f32 v10, s24, v10
    v_cvt_pk_bf16_f32 v103, v9, v10
    s_mov_b32 s52, 0
L_fb_t:
    s_lshl_b32 s35, s52, 13
    s_add_u32 m0, s53, 0
    s_add_u32 s36, s35, 0
    buffer_load_dwordx4 v4, s[12:15], s36 offen lds
    s_add_u32 m0, s53, 1056
    s_add_u32 s36, s35, 512
    buffer_load_dwordx4 v4, s[12:15], s36 offen lds
    s_add_u32 m0, s53, 2112
    s_add_u32 s36, s35, 1024
    buffer_load_dwordx4 v4, s[12:15], s36 offen lds
    s_add_u32 m0, s53, 3168
    s_add_u32 s36, s35, 1536
    buffer_load_dwordx4 v4, s[12:15], s36 offen lds
    s_add_u32 m0, s53, 4224
    s_add_u32 s36, s35, 128
    buffer_load_dwordx4 v4, s[12:15], s36 offen lds
    s_add_u32 m0, s53, 5280
    s_add_u32 s36, s35, 640
    buffer_load_dwordx4 v4, s[12:15], s36 offen lds
    s_add_u32 m0, s53, 6336
    s_add_u32 s36, s35, 1152
    buffer_load_dwordx4 v4, s[12:15], s36 offen lds
    s_add_u32 m0, s53, 7392
    s_add_u32 s36, s35, 1664
    buffer_load_dwordx4 v4, s[12:15], s36 offen lds
    s_add_u32 m0, s53, 8448
    s_add_u32 s36, s35, 0
    buffer_load_dwordx4 v4, s[16:19], s36 offen lds
    s_add_u32 m0, s53, 9504
    s_add_u32 s36, s35, 512
    buffer_load_dwordx4 v4, s[16:19], s36 offen lds
    s_add_u32 m0, s53, 10560
    s_add_u32 s36, s35, 1024
    buffer_load_dwordx4 v4, s[16:19], s36 offen lds
    s_add_u32 m0, s53, 11616
    s_add_u32 s36, s35, 1536
    buffer_load_dwordx4 v4, s[16:19], s36 offen lds
    s_add_u32 m0, s53, 12672
    s_add_u32 s36, s35, 128
    buffer_load_dwordx4 v4, s[16:19], s36 offen lds
    s_add_u32 m0, s53, 13728
    s_add_u32 s36, s35, 640
    buffer_load_dwordx4 v4, s[16:19], s36 offen lds
    s_add_u32 m0, s53, 14784
    s_add_u32 s36, s35, 1152
    buffer_load_dwordx4 v4, s[16:19], s36 offen lds
    s_add_u32 m0, s53, 15840
    s_add_u32 s36, s35, 1664
    buffer_load_dwordx4 v4, s[16:19], s36 offen lds
    s_waitcnt vmcnt(0)
    ds_read_b128 v[24:27], v2 offset:0
    ds_read_b128 v[28:31], v2 offset:64
    ds_read_b128 v[32:35], v2 offset:4224
    ds_read_b128 v[36:39], v2 offset:4288
    ds_read_b128 v[40:43], v2 offset:512
    ds_read_b128 v[44:47], v2 offset:576
    ds_read_b128 v[48:51], v2 offset:4736
    ds_read_b128 v[52:55], v2 offset:4800
    s_waitcnt lgkmcnt(0)
    ds_read_b64_tr_b16 v[56:57], v3 offset:8448
    ds_read_b64_tr_b16 v[58:59], v3 offset:8960
    ds_read_b64_tr_b16 v[60:61], v3 offset:8480
    ds_read_b64_tr_b16 v[62:63], v3 offset:8992
    ds_read_b64_tr_b16 v[64:65], v3 offset:8512
    ds_read_b64_tr_b16 v[66:67], v3 offset:9024
    ds_read_b64_tr_b16 v[68:69], v3 offset:8544
    ds_read_b64_tr_b16 v[70:71], v3 offset:9056
    ds_read_b64_tr_b16 v[72:73], v3 offset:12672
    ds_read_b64_tr_b16 v[74:75], v3 offset:13184
    ds_read_b64_tr_b16 v[76:77], v3 offset:12704
    ds_read_b64_tr_b16 v[78:79], v3 offset:13216
    ds_read_b64_tr_b16 v[80:81], v3 offset:12736
    ds_read_b64_tr_b16 v[82:83], v3 offset:13248
    ds_read_b64_tr_b16 v[84:85], v3 offset:12768
    ds_read_b64_tr_b16 v[86:87], v3 offset:13280
    v_mfma_f32_16x16x32_bf16 v[12:15], v[24:27], v[88:91], 0
    v_mfma_f32_16x16x32_bf16 v[12:15], v[28:31], v[92:95], v[12:15]
    v_mfma_f32_16x16x32_bf16 v[12:15], v[32:35], v[96:99], v[12:15]
    v_mfma_f32_16x16x32_bf16 v[12:15], v[36:39], v[100:103], v[12:15]
    v_mfma_f32_16x16x32_bf16 v[16:19], v[40:43], v[88:91], 0
    v_mfma_f32_16x16x32_bf16 v[16:19], v[44:47], v[92:95], v[16:19]
    v_mfma_f32_16x16x32_bf16 v[16:19], v[48:51], v[96:99], v[16:19]
    v_mfma_f32_16x16x32_bf16 v[16:19], v[52:55], v[100:103], v[16:19]
    s_nop 15
    v_max3_f32 v9, v12, v13, v14
    v_max3_f32 v10, v15, v16, v17
    v_max3_f32 v9, v9, v18, v19
    v_max3_f32 v9, v9, v10, v6
    v_mov_b32 v10, v9
    s_nop 1
    v_permlane32_swap_b32 v9, v10
    s_nop 1
    v_max_f32 v9, v9, v10
    v_mov_b32 v10, v9
    s_nop 1
    v_permlane16_swap_b32 v9, v10
    s_nop 1
    v_max_f32 v9, v9, v10
    v_sub_f32 v8, v6, v9
    v_mov_b32 v6, v9
    v_exp_f32 v8, v8
    v_sub_f32 v12, v12, v6
    v_sub_f32 v13, v13, v6
    v_sub_f32 v14, v14, v6
    v_sub_f32 v15, v15, v6
    v_sub_f32 v16, v16, v6
    v_sub_f32 v17, v17, v6
    v_sub_f32 v18, v18, v6
    v_sub_f32 v19, v19, v6
    v_exp_f32 v12, v12
    v_exp_f32 v13, v13
    v_exp_f32 v14, v14
    v_exp_f32 v15, v15
    v_exp_f32 v16, v16
    v_exp_f32 v17, v17
    v_exp_f32 v18, v18
    v_exp_f32 v19, v19
    v_mul_f32 v7, v7, v8
    v_mul_f32 v104, v104, v8
    v_mul_f32 v105, v105, v8
    v_mul_f32 v106, v106, v8
    v_mul_f32 v107, v107, v8
    v_mul_f32 v108, v108, v8
    v_mul_f32 v109, v109, v8
    v_mul_f32 v110, v110, v8
    v_mul_f32 v111, v111, v8
    v_mul_f32 v112, v112, v8
    v_mul_f32 v113, v113, v8
    v_mul_f32 v114, v114, v8
    v_mul_f32 v115, v115, v8
    v_mul_f32 v116, v116, v8
    v_mul_f32 v117, v117, v8
    v_mul_f32 v118, v118, v8
    v_mul_f32 v119, v119, v8
    v_mul_f32 v120, v120, v8
    v_mul_f32 v121, v121, v8
    v_mul_f32 v122, v122, v8
    v_mul_f32 v123, v123, v8
    v_mul_f32 v124, v124, v8
    v_mul_f32 v125, v125, v8
    v_mul_f32 v126, v126, v8
    v_mul_f32 v127, v127, v8
    v_mul_f32 v128, v128, v8
    v_mul_f32 v129, v129, v8
    v_mul_f32 v130, v130, v8
    v_mul_f32 v131, v131, v8
    v_mul_f32 v132, v132, v8
    v_mul_f32 v133, v133, v8
    v_mul_f32 v134, v134, v8
    v_mul_f32 v135, v135, v8
    v_add_f32 v7, v7, v12
    v_add_f32 v7, v7, v13
    v_add_f32 v7, v7, v14
    v_add_f32 v7, v7, v15
    v_add_f32 v7, v7, v16
    v_add_f32 v7, v7, v17
    v_add_f32 v7, v7, v18
    v_add_f32 v7, v7, v19
    v_cvt_pk_bf16_f32 v20, v12, v13
    v_cvt_pk_bf16_f32 v21, v14, v15
    v_cvt_pk_bf16_f32 v22, v16, v17
    v_cvt_pk_bf16_f32 v23, v18, v19
    s_waitcnt lgkmcnt(0)
    s_nop 1
    v_mfma_f32_16x16x32_bf16 v[104:107], v[56:59], v[20:23], v[104:107]
    v_mfma_f32_16x16x32_bf16 v[108:111], v[60:63], v[20:23], v[108:111]
    v_mfma_f32_16x16x32_bf16 v[112:115], v[64:67], v[20:23], v[112:115]
    v_mfma_f32_16x16x32_bf16 v[116:119], v[68:71], v[20:23], v[116:119]
    v_mfma_f32_16x16x32_bf16 v[120:123], v[72:75], v[20:23], v[120:123]
    v_mfma_f32_16x16x32_bf16 v[124:127], v[76:79], v[20:23], v[124:127]
    v_mfma_f32_16x16x32_bf16 v[128:131], v[80:83], v[20:23], v[128:131]
    v_mfma_f32_16x16x32_bf16 v[132:135], v[84:87], v[20:23], v[132:135]
    s_nop 15
    s_add_u32 s52, s52, 1
    s_cmp_lt_u32 s52, 32
    s_cbranch_scc1 L_fb_t
    v_mov_b32 v10, v7
    s_nop 1
    v_permlane32_swap_b32 v7, v10
    s_nop 1
    v_add_f32 v7, v7, v10
    v_mov_b32 v10, v7
    s_nop 1
    v_permlane16_swap_b32 v7, v10
    s_nop 1
    v_add_f32 v7, v7, v10
    v_rcp_f32 v7, v7
    s_nop 0
    v_mul_f32 v104, v104, v7
    v_mul_f32 v105, v105, v7
    v_mul_f32 v106, v106, v7
    v_mul_f32 v107, v107, v7
    v_mul_f32 v108, v108, v7
    v_mul_f32 v109, v109, v7
    v_mul_f32 v110, v110, v7
    v_mul_f32 v111, v111, v7
    v_mul_f32 v112, v112, v7
    v_mul_f32 v113, v113, v7
    v_mul_f32 v114, v114, v7
    v_mul_f32 v115, v115, v7
    v_mul_f32 v116, v116, v7
    v_mul_f32 v117, v117, v7
    v_mul_f32 v118, v118, v7
    v_mul_f32 v119, v119, v7
    v_mul_f32 v120, v120, v7
    v_mul_f32 v121, v121, v7
    v_mul_f32 v122, v122, v7
    v_mul_f32 v123, v123, v7
    v_mul_f32 v124, v124, v7
    v_mul_f32 v125, v125, v7
    v_mul_f32 v126, v126, v7
    v_mul_f32 v127, v127, v7
    v_mul_f32 v128, v128, v7
    v_mul_f32 v129, v129, v7
    v_mul_f32 v130, v130, v7
    v_mul_f32 v131, v131, v7
    v_mul_f32 v132, v132, v7
    v_mul_f32 v133, v133, v7
    v_mul_f32 v134, v134, v7
    v_mul_f32 v135, v135, v7
    v_cvt_pk_bf16_f32 v136, v104, v105
    v_cvt_pk_bf16_f32 v137, v106, v107
    v_cvt_pk_bf16_f32 v138, v108, v109
    v_cvt_pk_bf16_f32 v139, v110, v111
    v_cvt_pk_bf16_f32 v140, v112, v113
    v_cvt_pk_bf16_f32 v141, v114, v115
    v_cvt_pk_bf16_f32 v142, v116, v117
    v_cvt_pk_bf16_f32 v143, v118, v119
    v_cvt_pk_bf16_f32 v144, v120, v121
    v_cvt_pk_bf16_f32 v145, v122, v123
    v_cvt_pk_bf16_f32 v146, v124, v125
    v_cvt_pk_bf16_f32 v147, v126, v127
    v_cvt_pk_bf16_f32 v148, v128, v129
    v_cvt_pk_bf16_f32 v149, v130, v131
    v_cvt_pk_bf16_f32 v150, v132, v133
    v_cvt_pk_bf16_f32 v151, v134, v135
    s_nop 1
    v_permlane32_swap_b32 v136, v138
    v_permlane32_swap_b32 v137, v139
    v_permlane32_swap_b32 v140, v142
    v_permlane32_swap_b32 v141, v143
    v_permlane32_swap_b32 v144, v146
    v_permlane32_swap_b32 v145, v147
    v_permlane32_swap_b32 v148, v150
    v_permlane32_swap_b32 v149, v151
    s_nop 1
    v_permlane16_swap_b32 v136, v138
    v_permlane16_swap_b32 v137, v139
    v_permlane16_swap_b32 v140, v142
    v_permlane16_swap_b32 v141, v143
    v_permlane16_swap_b32 v144, v146
    v_permlane16_swap_b32 v145, v147
    v_permlane16_swap_b32 v148, v150
    v_permlane16_swap_b32 v149, v151
    s_nop 1
    buffer_store_dwordx4 v[136:139], v5, s[20:23], s34 offen offset:0
    buffer_store_dwordx4 v[140:143], v5, s[20:23], s34 offen offset:64
    buffer_store_dwordx4 v[144:147], v5, s[20:23], s34 offen offset:128
    buffer_store_dwordx4 v[148:151], v5, s[20:23], s34 offen offset:192
    s_waitcnt vmcnt(0)
    s_add_u32 s51, s51, 1
    s_cmp_lt_u32 s51, 9
    s_cbranch_scc1 L_fb_j
L_end:
    s_endpgm

.section .rodata,"a"
.p2align 6
.amdhsa_kernel standalone__mha_softmax__near_ridge_kernel
  .amdhsa_next_free_vgpr 512
  .amdhsa_next_free_sgpr 96
  .amdhsa_accum_offset 256
  .amdhsa_group_segment_fixed_size 0
  .amdhsa_kernarg_size 48
  .amdhsa_user_sgpr_count 2
  .amdhsa_user_sgpr_kernarg_segment_ptr 1
  .amdhsa_system_sgpr_workgroup_id_x 1
  .amdhsa_float_denorm_mode_32 3
.end_amdhsa_kernel
```
